```python
import torch

def _softmax(x, axis=-1):
    return torch.softmax(x, dim=axis)
def _gelu(x):
    return torch.nn.functional.gelu(x, approximate="tanh")
def _silu(x):
    return torch.nn.functional.silu(x)
def _sigmoid(x):
    return torch.sigmoid(x)
def _layernorm(x, axis=-1, eps=1e-5):
    m = x.mean(dim=axis, keepdim=True)
    v = x.var(dim=axis, keepdim=True, unbiased=False)
    return (x - m) / torch.sqrt(v + eps)
def _scatter_add(tgt, idx, src, axis=0):
    return tgt.clone().index_add_(axis, idx, src)
def _segment_sum(src, seg, n):
    out = torch.zeros((n,) + src.shape[1:], dtype=src.dtype)
    return out.index_add_(0, seg, src)
def _pad(x, pw):
    flat = tuple(v for pair in reversed(pw) for v in pair)
    return torch.nn.functional.pad(x, flat)

kernel_name = 'sequential_preLN__mha_block_cached__dense_activation_squared_relu__decode'

def setup_inputs():

    _w = (lambda a: (lambda t: t.to(torch.bfloat16) if t.is_floating_point() else t)(torch.as_tensor(a)))
    def _A_setup():
        B, Sq, D = 2, 1, 512
        H, Sk, Dh = 32, 4096, 128
        return {
            "x": _w((lambda *s: torch.randn(*s, dtype=torch.bfloat16) * 0.05)(B, Sq, D)),
            "k_cache": _w((lambda *s: torch.randn(*s, dtype=torch.bfloat16) * 3.2)(B, H, Sk, Dh)),
            "v_cache": _w((lambda *s: torch.randn(*s, dtype=torch.bfloat16) * 0.4)(B, H, Sk, Dh)),
            "wq": _w((lambda *s: torch.randn(*s, dtype=torch.bfloat16) * 3.2)(D, H * Dh) * (D ** -0.5)),
            "wo": _w((lambda *s: torch.randn(*s, dtype=torch.bfloat16) * 0.4)(H * Dh, D) * ((H * Dh) ** -0.5)),
        }
    _A_in = _A_setup()

    def _B_setup():
        B, S, D, F = 2, 1, 512, 1376
        return {
            "x": _w((lambda *s: torch.randn(*s, dtype=torch.bfloat16) * 0.05)(B, S, D)),
            "w1": _w((lambda *s: torch.randn(*s, dtype=torch.bfloat16) * 0.05)(D, F)),
            "b1": _w((lambda *s: torch.randn(*s, dtype=torch.bfloat16) * 0.8)(F)),
            "w2": _w((lambda *s: torch.randn(*s, dtype=torch.bfloat16) * 0.05)(F, D)),
            "b2": _w((lambda *s: torch.randn(*s, dtype=torch.bfloat16) * 3.2)(D)),
        }
    _B_in = _B_setup()

    return {
        "A_x": _A_in["x"],
        "A_k_cache": _A_in["k_cache"],
        "A_v_cache": _A_in["v_cache"],
        "A_wq": _A_in["wq"],
        "A_wo": _A_in["wo"],
        "B_x": _B_in["x"],
        "B_w1": _B_in["w1"],
        "B_b1": _B_in["b1"],
        "B_w2": _B_in["w2"],
        "B_b2": _B_in["b2"],
    }

def reference(A_x, A_k_cache, A_v_cache, A_wq, A_wo, B_x, B_w1, B_b1, B_w2, B_b2):
    def _A_ref(x, k_cache, v_cache, wq, wo):
        B, Sq, D = x.shape
        H, Dh = 32, 128
        q = (lambda x, *d: x.permute(*d))((x @ wq).reshape(B, Sq, H, Dh), 0, 2, 1, 3)
        scores = torch.einsum("bhqd,bhkd->bhqk", q, k_cache) * (Dh ** -0.5)
        p = _softmax(scores, axis=-1)
        o = torch.einsum("bhqk,bhkd->bhqd", p, v_cache)
        return (lambda x, *d: x.permute(*d))(o, 0, 2, 1, 3).reshape(B, Sq, H * Dh) @ wo

    def _B_ref(x, w1, b1, w2, b2):
        h = torch.einsum("bsd,df->bsf", x, w1) + b1
        zero = torch.zeros_like(h)
        r = torch.where(h > zero, h, zero)
        h = r * r
        out = torch.einsum("bsf,fd->bsd", h, w2) + b2
        return out

    x = A_x
    h = x + _A_ref(_layernorm(x, axis=-1), A_k_cache, A_v_cache, A_wq, A_wo)
    h2 = h + _B_ref(_layernorm(h, axis=-1), B_w1, B_b1, B_w2, B_b2)
    return h2
```

```asm
; @launch grid=(256,1,1) block=(512,1,1) lds=143360
.amdgcn_target "amdgcn-amd-amdhsa--gfx950"
.text
.globl sequential_preLN__mha_block_cached__dense_activation_squared_relu__decode_kernel
.p2align 8
.type sequential_preLN__mha_block_cached__dense_activation_squared_relu__decode_kernel,@function
sequential_preLN__mha_block_cached__dense_activation_squared_relu__decode_kernel:
  s_load_dwordx16 s[4:19], s[0:1], 0
  s_load_dwordx8 s[20:27], s[0:1], 64
  s_load_dwordx2 s[28:29], s[0:1], 96
  s_lshr_b32 s36, s2, 8
  s_cbranch_scc1 L_end
  s_and_b32 s31, s2, 31
  s_lshr_b32 s34, s2, 5
  s_lshl3_add_u32 s62, s31, s34
  s_lshl_b32 s36, s62, 14
  v_lshlrev_b32 v10, 4, v0
  v_mov_b32 v26, 0
  ds_write_b32 v10, v26
  v_lshl_add_u32 v9, v0, 5, s36
  s_mul_i32 s36, s2, 5504
  v_min_u32 v11, 5488, v10
  v_add_u32 v11, s36, v11
  s_waitcnt lgkmcnt(0)
  global_load_dword v250, v9, s[12:13]
  global_load_dword v251, v11, s[16:17]
  s_barrier
  v_lshrrev_b32 v2, 6, v0
  v_and_b32 v1, 63, v0
  s_lshr_b32 s32, s2, 7
  v_readfirstlane_b32 s30, v2
  v_and_b32 v2, 15, v1
  v_lshrrev_b32 v3, 4, v1
  v_lshlrev_b32 v8, 4, v1
  s_and_b32 s35, s30, 3
  s_mov_b64 s[56:57], s[28:29]
  s_mov_b32 s58, 786432
  s_mov_b32 s59, 0x20000
  s_cmp_lt_u32 s30, 4
  s_cbranch_scc1 L_stream
  s_cmp_eq_u32 s30, 4
  s_cbranch_scc1 L_q1
  s_cmp_eq_u32 s30, 6
  s_cselect_b32 s36, s2, 64
  s_cmp_lt_u32 s36, 64
  s_cbranch_scc0 L_other
  v_mov_b32 v16, -1
  v_mov_b32 v17, -1
  v_mov_b32 v18, -1
  v_mov_b32 v19, -1
  s_mul_i32 s36, s2, 3712
  buffer_store_dwordx4 v[16:19], v8, s[56:59], s36 offen offset:0 sc1
  buffer_store_dwordx4 v[16:19], v8, s[56:59], s36 offen offset:1024 sc1
  buffer_store_dwordx4 v[16:19], v8, s[56:59], s36 offen offset:2048 sc1
  s_mov_b32 exec_hi, 0xff
  buffer_store_dwordx4 v[16:19], v8, s[56:59], s36 offen offset:3072 sc1
  s_mov_b32 exec_hi, -1
  s_branch L_other
L_q1:
  s_setprio 2
  v_mov_b32 v16, -1
  v_mov_b32 v17, -1
  v_mov_b32 v18, -1
  v_mov_b32 v19, -1
  s_lshl_b32 s96, s62, 7
  s_add_u32 s96, s96, 393216
  s_mov_b64 exec, 0xff
  buffer_store_dwordx4 v[16:19], v8, s[56:59], s96 offen
  s_mov_b64 exec, -1
  v_lshlrev_b32 v12, 5, v1
  s_mov_b64 s[40:41], s[4:5]
  s_mov_b32 s42, 2048
  s_mov_b32 s43, 0x20000
  buffer_load_dwordx4 v[20:23], v12, s[40:43], 0 offen
  buffer_load_dwordx4 v[128:131], v12, s[40:43], 0 offen offset:16
  v_lshlrev_b32 v11, 13, v3
  v_lshl_add_u32 v11, v2, 4, v11
  v_lshl_add_u32 v63, v2, 2, v3
  v_lshlrev_b32 v63, 1, v63
  s_lshl_b32 s36, s31, 8
  s_lshl_b32 s60, s34, 19
  s_add_u32 s44, s10, s36
  s_addc_u32 s45, s11, 0
  s_mov_b32 s46, 4186368
  s_mov_b32 s47, 0x20000
  s_mov_b32 s71, 0
L_qload:
  s_lshr_b32 s38, s60, 12
  buffer_load_ushort v14, v63, s[40:43], s38 offen
  buffer_load_ushort v15, v63, s[40:43], s38 offen offset:1024
  buffer_load_dwordx4 v[64:67], v11, s[44:47], s60 offen nt
  s_add_u32 s60, s60, 0x8000
  buffer_load_dwordx4 v[68:71], v11, s[44:47], s60 offen nt
  s_add_u32 s60, s60, 0x8000
  buffer_load_dwordx4 v[72:75], v11, s[44:47], s60 offen nt
  s_add_u32 s60, s60, 0x8000
  buffer_load_dwordx4 v[76:79], v11, s[44:47], s60 offen nt
  s_add_u32 s60, s60, 0x8000
  buffer_load_dwordx4 v[80:83], v11, s[44:47], s60 offen nt
  s_add_u32 s60, s60, 0x8000
  buffer_load_dwordx4 v[84:87], v11, s[44:47], s60 offen nt
  s_add_u32 s60, s60, 0x8000
  buffer_load_dwordx4 v[88:91], v11, s[44:47], s60 offen nt
  s_add_u32 s60, s60, 0x8000
  buffer_load_dwordx4 v[92:95], v11, s[44:47], s60 offen nt
  s_add_u32 s60, s60, 0x8000
  buffer_load_dwordx4 v[96:99], v11, s[44:47], s60 offen nt
  s_add_u32 s60, s60, 0x8000
  buffer_load_dwordx4 v[100:103], v11, s[44:47], s60 offen nt
  s_add_u32 s60, s60, 0x8000
  buffer_load_dwordx4 v[104:107], v11, s[44:47], s60 offen nt
  s_add_u32 s60, s60, 0x8000
  buffer_load_dwordx4 v[108:111], v11, s[44:47], s60 offen nt
  s_add_u32 s60, s60, 0x8000
  buffer_load_dwordx4 v[112:115], v11, s[44:47], s60 offen nt
  s_add_u32 s60, s60, 0x8000
  buffer_load_dwordx4 v[116:119], v11, s[44:47], s60 offen nt
  s_add_u32 s60, s60, 0x8000
  buffer_load_dwordx4 v[120:123], v11, s[44:47], s60 offen nt
  s_add_u32 s60, s60, 0x8000
  buffer_load_dwordx4 v[124:127], v11, s[44:47], s60 offen nt
  s_add_u32 s60, s60, 0x8000
  s_branch L_q2
L_stream:
  s_lshl_b32 s36, s32, 5
  s_add_u32 s36, s36, s31
  s_lshl_b32 s36, s36, 20
  s_add_u32 s40, s6, s36
  s_addc_u32 s41, s7, 0
  s_mov_b32 s42, 1048576
  s_mov_b32 s43, 0x20000
  s_bitcmp1_b32 s35, 0
  s_cselect_b32 s97, 0x2000, 0
  s_bitcmp1_b32 s35, 1
  s_cselect_b32 s38, 0x1800, 0
  s_xor_b32 s97, s97, s38
  s_bitcmp1_b32 s2, 5
  s_cselect_b32 s38, 0x8000, 0
  s_xor_b32 s97, s97, s38
  s_bitcmp1_b32 s2, 6
  s_cselect_b32 s38, 0x4000, 0
  s_xor_b32 s97, s97, s38
  s_bitcmp1_b32 s2, 0
  s_cselect_b32 s38, 0x4c00, 0
  s_xor_b32 s97, s97, s38
  s_bitcmp1_b32 s2, 1
  s_cselect_b32 s38, 0x40000, 0
  s_xor_b32 s97, s97, s38
  s_bitcmp1_b32 s2, 2
  s_cselect_b32 s38, 0x40000, 0
  s_xor_b32 s97, s97, s38
  s_bitcmp1_b32 s2, 3
  s_cselect_b32 s38, 0x40000, 0
  s_xor_b32 s97, s97, s38
  s_bitcmp1_b32 s2, 4
  s_cselect_b32 s38, 0x44000, 0
  s_xor_b32 s97, s97, s38
  s_xor_b32 s60, s97, 0x0
  buffer_load_dwordx4 v[64:67], v8, s[40:43], s60 offen nt
  s_xor_b32 s60, s97, 0x2400
  buffer_load_dwordx4 v[68:71], v8, s[40:43], s60 offen nt
  s_add_u32 s44, s8, s36
  s_addc_u32 s45, s9, 0
  s_mov_b32 s46, 1048576
  s_mov_b32 s47, 0x20000
  s_and_b32 s68, s2, 7
  s_lshr_b32 s69, s2, 3
  s_getreg_b32 s63, hwreg(HW_REG_XCC_ID, 0, 3)
  s_or_b32 s63, s63, 0x80
  v_mov_b32 v27, 1
  s_cmp_lt_u32 s69, 30
  s_cselect_b32 s99, 2, 0
  s_cmp_eq_u32 s68, 2
  s_cselect_b32 s99, s99, 0
  s_cmp_lt_u32 s69, 8
  s_cselect_b32 s99, 1, s99
  s_lshl_b32 s62, s62, 9
  s_mov_b32 s66, 0x3fb8aa3b
  s_mov_b32 s67, 0x3db504f3
  s_cmp_eq_u32 s68, 2
  s_cselect_b32 s98, 8, 0
  s_cmp_eq_u32 s99, 1
  s_cselect_b32 s37, 5, 0
  s_add_u32 s98, s98, s37
  s_cmp_eq_u32 s99, 2
  s_cselect_b32 s98, 28, s98
  s_lshl_b32 s96, s68, 5
  s_add_u32 s96, s96, s69
  s_lshl2_add_u32 s96, s96, s35
  s_add_u32 s96, s96, 425984
  v_and_b32 v10, 1, v2
  v_lshlrev_b32 v10, 4, v10
  v_mov_b32 v9, 0xffff
  v_lshlrev_b32 v10, v10, v9
  v_lshrrev_b32 v9, 1, v2
  v_cmp_eq_u32 vcc, 0, v9
  s_nop 1
  v_cndmask_b32 v4, 0, v10, vcc
  v_cmp_eq_u32 vcc, 1, v9
  s_nop 1
  v_cndmask_b32 v5, 0, v10, vcc
  v_cmp_eq_u32 vcc, 2, v9
  s_nop 1
  v_cndmask_b32 v6, 0, v10, vcc
  v_cmp_eq_u32 vcc, 3, v9
  s_nop 1
  v_cndmask_b32 v7, 0, v10, vcc
  v_lshlrev_b32 v9, 4, v2
  v_lshrrev_b32 v11, 1, v8
  s_lshl_b32 s37, s35, 9
  v_add_u32 v10, s37, v8
  v_mov_b32 v22, 0xff800000
  s_xor_b32 s60, s97, 0xc00
  buffer_load_dwordx4 v[72:75], v8, s[40:43], s60 offen nt
  s_xor_b32 s60, s97, 0x2800
  s_waitcnt vmcnt(4)
  buffer_load_dwordx4 v[76:79], v8, s[40:43], s60 offen nt
  s_xor_b32 s60, s97, 0x1c400
  s_waitcnt vmcnt(4)
  buffer_load_dwordx4 v[80:83], v8, s[40:43], s60 offen nt
  s_xor_b32 s60, s97, 0x1e000
  s_waitcnt vmcnt(4)
  buffer_load_dwordx4 v[84:87], v8, s[40:43], s60 offen nt
  s_xor_b32 s60, s97, 0x1c800
  s_cmp_gt_u32 s98, 6
  s_waitcnt vmcnt(5)
  s_cbranch_scc1 L_w6
  s_waitcnt vmcnt(4)
L_w6:
  buffer_load_dwordx4 v[88:91], v8, s[40:43], s60 offen nt
  s_xor_b32 s60, s97, 0x1ec00
  s_cmp_gt_u32 s98, 7
  s_waitcnt vmcnt(5)
  s_cbranch_scc1 L_w7
  s_waitcnt vmcnt(4)
L_w7:
  buffer_load_dwordx4 v[92:95], v8, s[40:43], s60 offen nt
  s_xor_b32 s60, s97, 0x40800
  s_cmp_gt_u32 s98, 8
  s_waitcnt vmcnt(5)
  s_cbranch_scc1 L_w8
  s_waitcnt vmcnt(4)
L_w8:
  buffer_load_dwordx4 v[96:99], v8, s[40:43], s60 offen nt
  s_xor_b32 s60, s97, 0x42c00
  s_cmp_gt_u32 s98, 9
  s_waitcnt vmcnt(5)
  s_cbranch_scc1 L_w9
  s_waitcnt vmcnt(4)
L_w9:
  buffer_load_dwordx4 v[100:103], v8, s[40:43], s60 offen nt
  s_xor_b32 s60, s97, 0x40400
  s_cmp_gt_u32 s98, 10
  s_waitcnt vmcnt(5)
  s_cbranch_scc1 L_w10
  s_waitcnt vmcnt(4)
L_w10:
  buffer_load_dwordx4 v[104:107], v8, s[40:43], s60 offen nt
  s_xor_b32 s60, s97, 0x42000
  s_cmp_gt_u32 s98, 11
  s_waitcnt vmcnt(5)
  s_cbranch_scc1 L_w11
  s_waitcnt vmcnt(4)
L_w11:
  buffer_load_dwordx4 v[108:111], v8, s[40:43], s60 offen nt
  s_xor_b32 s60, s97, 0x5cc00
  s_cmp_gt_u32 s98, 12
  s_waitcnt vmcnt(5)
  s_cbranch_scc1 L_w12
  s_waitcnt vmcnt(4)
L_w12:
  buffer_load_dwordx4 v[112:115], v8, s[40:43], s60 offen nt
  s_xor_b32 s60, s97, 0x5e800
  s_cmp_gt_u32 s98, 13
  s_waitcnt vmcnt(5)
  s_cbranch_scc1 L_w13
  s_waitcnt vmcnt(4)
L_w13:
  buffer_load_dwordx4 v[116:119], v8, s[40:43], s60 offen nt
  s_xor_b32 s60, s97, 0x5c000
  s_cmp_gt_u32 s98, 14
  s_waitcnt vmcnt(5)
  s_cbranch_scc1 L_w14
  s_waitcnt vmcnt(4)
L_w14:
  buffer_load_dwordx4 v[120:123], v8, s[40:43], s60 offen nt
  s_xor_b32 s60, s97, 0x5e400
  s_cmp_gt_u32 s98, 15
  s_waitcnt vmcnt(5)
  s_cbranch_scc1 L_w15
  s_waitcnt vmcnt(4)
L_w15:
  buffer_load_dwordx4 v[124:127], v8, s[40:43], s60 offen nt
  s_xor_b32 s60, s97, 0x20400
  s_cmp_gt_u32 s98, 16
  s_waitcnt vmcnt(5)
  s_cbranch_scc1 L_w16
  s_waitcnt vmcnt(4)
L_w16:
  buffer_load_dwordx4 v[128:131], v8, s[40:43], s60 offen nt
  s_xor_b32 s60, s97, 0x22000
  s_cmp_gt_u32 s98, 17
  s_waitcnt vmcnt(5)
  s_cbranch_scc1 L_w17
  s_waitcnt vmcnt(4)
L_w17:
  buffer_load_dwordx4 v[132:135], v8, s[40:43], s60 offen nt
  s_xor_b32 s60, s97, 0x20800
  s_cmp_gt_u32 s98, 18
  s_waitcnt vmcnt(5)
  s_cbranch_scc1 L_w18
  s_waitcnt vmcnt(4)
L_w18:
  buffer_load_dwordx4 v[136:139], v8, s[40:43], s60 offen nt
  s_xor_b32 s60, s97, 0x22c00
  s_cmp_gt_u32 s98, 19
  s_waitcnt vmcnt(5)
  s_cbranch_scc1 L_w19
  s_waitcnt vmcnt(4)
L_w19:
  buffer_load_dwordx4 v[140:143], v8, s[40:43], s60 offen nt
  s_xor_b32 s60, s97, 0x3c000
  s_cmp_gt_u32 s98, 20
  s_waitcnt vmcnt(5)
  s_cbranch_scc1 L_w20
  s_waitcnt vmcnt(4)
L_w20:
  buffer_load_dwordx4 v[144:147], v8, s[40:43], s60 offen nt
  s_mov_b64 exec, 1
  ds_add_u32 v26, v27 offset:160
  s_mov_b64 exec, -1
  s_xor_b32 s60, s97, 0x3e400
  s_cmp_gt_u32 s98, 21
  s_waitcnt vmcnt(5)
  s_cbranch_scc1 L_w21
  s_waitcnt vmcnt(4)
L_w21:
  buffer_load_dwordx4 v[148:151], v8, s[40:43], s60 offen nt
  s_xor_b32 s60, s97, 0x3cc00
  s_cmp_gt_u32 s98, 22
  s_waitcnt vmcnt(5)
  s_cbranch_scc1 L_w22
  s_waitcnt vmcnt(4)
L_w22:
  buffer_load_dwordx4 v[152:155], v8, s[40:43], s60 offen nt
  s_xor_b32 s60, s97, 0x3e800
  s_cmp_gt_u32 s98, 23
  s_waitcnt vmcnt(5)
  s_cbranch_scc1 L_w23
  s_waitcnt vmcnt(4)
L_w23:
  buffer_load_dwordx4 v[156:159], v8, s[40:43], s60 offen nt
  s_xor_b32 s60, s97, 0x60c00
  s_cmp_gt_u32 s98, 24
  s_waitcnt vmcnt(5)
  s_cbranch_scc1 L_w24
  s_waitcnt vmcnt(4)
L_w24:
  buffer_load_dwordx4 v[160:163], v8, s[40:43], s60 offen nt
  s_xor_b32 s60, s97, 0x62800
  s_cmp_gt_u32 s98, 25
  s_waitcnt vmcnt(5)
  s_cbranch_scc1 L_w25
  s_waitcnt vmcnt(4)
L_w25:
  buffer_load_dwordx4 v[164:167], v8, s[40:43], s60 offen nt
  s_xor_b32 s60, s97, 0x60000
  s_cmp_gt_u32 s98, 26
  s_waitcnt vmcnt(5)
  s_cbranch_scc1 L_w26
  s_waitcnt vmcnt(4)
L_w26:
  buffer_load_dwordx4 v[168:171], v8, s[40:43], s60 offen nt
  s_xor_b32 s60, s97, 0x62400
  s_cmp_gt_u32 s98, 27
  s_waitcnt vmcnt(5)
  s_cbranch_scc1 L_w27
  s_waitcnt vmcnt(4)
L_w27:
  buffer_load_dwordx4 v[172:175], v8, s[40:43], s60 offen nt
  s_xor_b32 s60, s97, 0x7c800
  s_waitcnt vmcnt(4)
  buffer_load_dwordx4 v[176:179], v8, s[40:43], s60 offen nt
  s_xor_b32 s60, s97, 0x7ec00
  s_waitcnt vmcnt(4)
  buffer_load_dwordx4 v[180:183], v8, s[40:43], s60 offen nt
  s_xor_b32 s60, s97, 0x7c400
  s_waitcnt vmcnt(4)
  buffer_load_dwordx4 v[184:187], v8, s[40:43], s60 offen nt
  s_mov_b64 exec, 1
  ds_add_u32 v26, v27 offset:160
  s_mov_b64 exec, -1
  s_xor_b32 s60, s97, 0x7e000
  s_waitcnt vmcnt(4)
  buffer_load_dwordx4 v[188:191], v8, s[40:43], s60 offen nt
  s_xor_b32 s60, s97, 0x80000
  s_cmp_gt_u32 s98, 0
  s_waitcnt vmcnt(5)
  s_cbranch_scc1 L_w32
  s_waitcnt vmcnt(4)
L_w32:
  buffer_load_dwordx4 v[192:195], v8, s[40:43], s60 offen nt
  s_xor_b32 s60, s97, 0x82400
  s_cmp_gt_u32 s98, 1
  s_waitcnt vmcnt(5)
  s_cbranch_scc1 L_w33
  s_waitcnt vmcnt(4)
L_w33:
  buffer_load_dwordx4 v[196:199], v8, s[40:43], s60 offen nt
  s_xor_b32 s60, s97, 0x80c00
  s_cmp_gt_u32 s98, 2
  s_waitcnt vmcnt(5)
  s_cbranch_scc1 L_w34
  s_waitcnt vmcnt(4)
L_w34:
  buffer_load_dwordx4 v[200:203], v8, s[40:43], s60 offen nt
  s_xor_b32 s60, s97, 0x82800
  s_cmp_gt_u32 s98, 3
  s_waitcnt vmcnt(5)
  s_cbranch_scc1 L_w35
  s_waitcnt vmcnt(4)
L_w35:
  buffer_load_dwordx4 v[204:207], v8, s[40:43], s60 offen nt
  s_xor_b32 s60, s97, 0x9c400
  s_cmp_gt_u32 s98, 4
  s_waitcnt vmcnt(5)
  s_cbranch_scc1 L_w36
  s_waitcnt vmcnt(4)
L_w36:
  buffer_load_dwordx4 v[208:211], v8, s[40:43], s60 offen nt
  s_xor_b32 s60, s97, 0x9e000
  s_cmp_gt_u32 s98, 5
  s_waitcnt vmcnt(5)
  s_cbranch_scc1 L_w37
  s_waitcnt vmcnt(4)
L_w37:
  buffer_load_dwordx4 v[212:215], v8, s[40:43], s60 offen nt
  s_xor_b32 s60, s97, 0x9c800
  s_cmp_gt_u32 s98, 6
  s_waitcnt vmcnt(5)
  s_cbranch_scc1 L_w38
  s_waitcnt vmcnt(4)
L_w38:
  buffer_load_dwordx4 v[216:219], v8, s[40:43], s60 offen nt
  ds_read2_b32 v[44:45], v26 offset0:44 offset1:52
  s_xor_b32 s60, s97, 0x9ec00
  s_cmp_gt_u32 s98, 7
  s_waitcnt vmcnt(5)
  s_cbranch_scc1 L_w39
  s_waitcnt vmcnt(4)
L_w39:
  buffer_load_dwordx4 v[220:223], v8, s[40:43], s60 offen nt
  s_waitcnt lgkmcnt(0)
  v_readfirstlane_b32 s64, v44
  v_readfirstlane_b32 s65, v45
  s_xor_b32 s60, s97, 0xc0800
  s_bitcmp1_b32 s64, 31
  s_waitcnt vmcnt(6)
  s_cbranch_scc1 L_w40
  s_bitcmp0_b32 s65, 31
  s_waitcnt vmcnt(4)
  s_cbranch_scc1 L_w40
  s_waitcnt vmcnt(3)
L_w40:
  buffer_load_dwordx4 v[224:227], v8, s[40:43], s60 offen nt
  s_xor_b32 s60, s97, 0xc2c00
  s_bitcmp1_b32 s64, 30
  s_waitcnt vmcnt(6)
  s_cbranch_scc1 L_w41
  s_bitcmp0_b32 s65, 30
  s_waitcnt vmcnt(4)
  s_cbranch_scc1 L_w41
  s_waitcnt vmcnt(3)
L_w41:
  buffer_load_dwordx4 v[228:231], v8, s[40:43], s60 offen nt
  s_xor_b32 s60, s97, 0xc0400
  s_bitcmp1_b32 s64, 29
  s_waitcnt vmcnt(6)
  s_cbranch_scc1 L_w42
  s_bitcmp0_b32 s65, 29
  s_waitcnt vmcnt(4)
  s_cbranch_scc1 L_w42
  s_waitcnt vmcnt(3)
L_w42:
  buffer_load_dwordx4 v[232:235], v8, s[40:43], s60 offen nt
  ds_read2_b32 v[44:45], v26 offset0:44 offset1:52
  s_xor_b32 s60, s97, 0xc2000
  s_bitcmp1_b32 s64, 28
  s_waitcnt vmcnt(6)
  s_cbranch_scc1 L_w43
  s_bitcmp0_b32 s65, 28
  s_waitcnt vmcnt(4)
  s_cbranch_scc1 L_w43
  s_waitcnt vmcnt(3)
L_w43:
  buffer_load_dwordx4 v[236:239], v8, s[40:43], s60 offen nt
  s_waitcnt lgkmcnt(0)
  v_readfirstlane_b32 s64, v44
  v_readfirstlane_b32 s65, v45
  s_xor_b32 s60, s97, 0xdcc00
  s_bitcmp1_b32 s64, 27
  s_waitcnt vmcnt(6)
  s_cbranch_scc1 L_w44
  s_bitcmp0_b32 s65, 27
  s_waitcnt vmcnt(4)
  s_cbranch_scc1 L_w44
  s_waitcnt vmcnt(3)
L_w44:
  buffer_load_dwordx4 v[240:243], v8, s[40:43], s60 offen nt
  s_xor_b32 s60, s97, 0xde800
  s_bitcmp1_b32 s64, 26
  s_waitcnt vmcnt(6)
  s_cbranch_scc1 L_w45
  s_bitcmp0_b32 s65, 26
  s_waitcnt vmcnt(4)
  s_cbranch_scc1 L_w45
  s_waitcnt vmcnt(3)
L_w45:
  buffer_load_dwordx4 v[244:247], v8, s[40:43], s60 offen nt
L_qspin:
  ds_read_b32 v24, v26 offset:64
  ds_read_b128 v[12:15], v9 offset:224
  s_waitcnt lgkmcnt(0)
  v_cmp_ne_u32 vcc, 1, v24
  s_cbranch_vccnz L_qspin
  v_dot2_f32_bf16 v16, v64, v12, 0
  v_dot2_f32_bf16 v16, v65, v13, v16
  v_dot2_f32_bf16 v16, v66, v14, v16
  v_dot2_f32_bf16 v16, v67, v15, v16
  s_xor_b32 s60, s97, 0xdc000
  s_bitcmp1_b32 s64, 25
  s_waitcnt vmcnt(6)
  s_cbranch_scc1 L_w46
  s_bitcmp0_b32 s65, 25
  s_waitcnt vmcnt(4)
  s_cbranch_scc1 L_w46
  s_waitcnt vmcnt(3)
L_w46:
  buffer_load_dwordx4 v[64:67], v8, s[40:43], s60 offen nt
  v_dot2_f32_bf16 v17, v68, v12, 0
  v_dot2_f32_bf16 v17, v69, v13, v17
  v_dot2_f32_bf16 v17, v70, v14, v17
  v_dot2_f32_bf16 v17, v71, v15, v17
  v_dot2_f32_bf16 v18, v72, v12, 0
  v_dot2_f32_bf16 v18, v73, v13, v18
  v_dot2_f32_bf16 v18, v74, v14, v18
  v_dot2_f32_bf16 v18, v75, v15, v18
  v_dot2_f32_bf16 v19, v76, v12, 0
  v_dot2_f32_bf16 v19, v77, v13, v19
  v_dot2_f32_bf16 v19, v78, v14, v19
  v_dot2_f32_bf16 v19, v79, v15, v19
  s_xor_b32 s60, s97, 0xde400
  s_bitcmp1_b32 s64, 24
  s_waitcnt vmcnt(6)
  s_cbranch_scc1 L_w47
  s_bitcmp0_b32 s65, 24
  s_waitcnt vmcnt(4)
  s_cbranch_scc1 L_w47
  s_waitcnt vmcnt(3)
L_w47:
  buffer_load_dwordx4 v[68:71], v8, s[40:43], s60 offen nt
  v_add_f32_dpp v20, v16, v16 row_ror:8 row_mask:0xf bank_mask:0x3
  v_add_f32_dpp v21, v17, v17 row_ror:8 row_mask:0xf bank_mask:0x3
  v_add_f32_dpp v20, v18, v18 row_ror:8 row_mask:0xf bank_mask:0xc
  v_add_f32_dpp v21, v19, v19 row_ror:8 row_mask:0xf bank_mask:0xc
  s_nop 0
  v_add_f32_dpp v48, v20, v20 row_shl:4 row_mask:0xf bank_mask:0x5
  v_add_f32_dpp v48, v21, v21 row_shr:4 row_mask:0xf bank_mask:0xa
  s_nop 1
  v_add_f32_dpp v48, v48, v48 quad_perm:[1,0,3,2] row_mask:0xf bank_mask:0xf
  s_nop 1
  v_add_f32_dpp v48, v48, v48 quad_perm:[2,3,0,1] row_mask:0xf bank_mask:0xf
  v_cvt_pk_bf16_f32 v48, v48, v48
  v_lshlrev_b32 v48, 16, v48
  v_mul_f32 v48, s67, v48
  v_cvt_pk_bf16_f32 v48, v48, v48
  v_lshlrev_b32 v48, 16, v48
  v_max_f32 v22, v22, v48
  v_dot2_f32_bf16 v16, v80, v12, 0
  v_dot2_f32_bf16 v16, v81, v13, v16
  v_dot2_f32_bf16 v16, v82, v14, v16
  v_dot2_f32_bf16 v16, v83, v15, v16
  v_dot2_f32_bf16 v17, v84, v12, 0
  v_dot2_f32_bf16 v17, v85, v13, v17
  v_dot2_f32_bf16 v17, v86, v14, v17
  v_dot2_f32_bf16 v17, v87, v15, v17
  s_xor_b32 s60, s97, 0xa0400
  s_bitcmp1_b32 s64, 23
  s_waitcnt vmcnt(6)
  s_cbranch_scc1 L_w48
  s_bitcmp0_b32 s65, 23
  s_waitcnt vmcnt(4)
  s_cbranch_scc1 L_w48
  s_waitcnt vmcnt(3)
L_w48:
  buffer_load_dwordx4 v[72:75], v8, s[40:43], s60 offen nt
  v_dot2_f32_bf16 v18, v88, v12, 0
  v_dot2_f32_bf16 v18, v89, v13, v18
  v_dot2_f32_bf16 v18, v90, v14, v18
  v_dot2_f32_bf16 v18, v91, v15, v18
  v_dot2_f32_bf16 v19, v92, v12, 0
  v_dot2_f32_bf16 v19, v93, v13, v19
  v_dot2_f32_bf16 v19, v94, v14, v19
  v_dot2_f32_bf16 v19, v95, v15, v19
  v_add_f32_dpp v20, v16, v16 row_ror:8 row_mask:0xf bank_mask:0x3
  v_add_f32_dpp v21, v17, v17 row_ror:8 row_mask:0xf bank_mask:0x3
  v_add_f32_dpp v20, v18, v18 row_ror:8 row_mask:0xf bank_mask:0xc
  v_add_f32_dpp v21, v19, v19 row_ror:8 row_mask:0xf bank_mask:0xc
  s_nop 0
  v_add_f32_dpp v49, v20, v20 row_shl:4 row_mask:0xf bank_mask:0x5
  v_add_f32_dpp v49, v21, v21 row_shr:4 row_mask:0xf bank_mask:0xa
  s_nop 1
  v_add_f32_dpp v49, v49, v49 quad_perm:[1,0,3,2] row_mask:0xf bank_mask:0xf
  s_nop 1
  v_add_f32_dpp v49, v49, v49 quad_perm:[2,3,0,1] row_mask:0xf bank_mask:0xf
  v_cvt_pk_bf16_f32 v49, v49, v49
  v_lshlrev_b32 v49, 16, v49
  v_mul_f32 v49, s67, v49
  v_cvt_pk_bf16_f32 v49, v49, v49
  v_lshlrev_b32 v49, 16, v49
  v_max_f32 v22, v22, v49
  s_xor_b32 s60, s97, 0xa2000
  s_bitcmp1_b32 s64, 22
  s_waitcnt vmcnt(6)
  s_cbranch_scc1 L_w49
  s_bitcmp0_b32 s65, 22
  s_waitcnt vmcnt(4)
  s_cbranch_scc1 L_w49
  s_waitcnt vmcnt(3)
L_w49:
  buffer_load_dwordx4 v[76:79], v8, s[40:43], s60 offen nt
  v_dot2_f32_bf16 v16, v96, v12, 0
  v_dot2_f32_bf16 v16, v97, v13, v16
  v_dot2_f32_bf16 v16, v98, v14, v16
  v_dot2_f32_bf16 v16, v99, v15, v16
  v_dot2_f32_bf16 v17, v100, v12, 0
  v_dot2_f32_bf16 v17, v101, v13, v17
  v_dot2_f32_bf16 v17, v102, v14, v17
  v_dot2_f32_bf16 v17, v103, v15, v17
  v_dot2_f32_bf16 v18, v104, v12, 0
  v_dot2_f32_bf16 v18, v105, v13, v18
  v_dot2_f32_bf16 v18, v106, v14, v18
  v_dot2_f32_bf16 v18, v107, v15, v18
  v_dot2_f32_bf16 v19, v108, v12, 0
  v_dot2_f32_bf16 v19, v109, v13, v19
  v_dot2_f32_bf16 v19, v110, v14, v19
  v_dot2_f32_bf16 v19, v111, v15, v19
  s_xor_b32 s60, s97, 0xa0800
  s_bitcmp1_b32 s64, 21
  s_waitcnt vmcnt(6)
  s_cbranch_scc1 L_w50
  s_bitcmp0_b32 s65, 21
  s_waitcnt vmcnt(4)
  s_cbranch_scc1 L_w50
  s_waitcnt vmcnt(3)
L_w50:
  buffer_load_dwordx4 v[80:83], v8, s[40:43], s60 offen nt
  v_add_f32_dpp v20, v16, v16 row_ror:8 row_mask:0xf bank_mask:0x3
  v_add_f32_dpp v21, v17, v17 row_ror:8 row_mask:0xf bank_mask:0x3
  v_add_f32_dpp v20, v18, v18 row_ror:8 row_mask:0xf bank_mask:0xc
  v_add_f32_dpp v21, v19, v19 row_ror:8 row_mask:0xf bank_mask:0xc
  s_nop 0
  v_add_f32_dpp v50, v20, v20 row_shl:4 row_mask:0xf bank_mask:0x5
  v_add_f32_dpp v50, v21, v21 row_shr:4 row_mask:0xf bank_mask:0xa
  s_nop 1
  v_add_f32_dpp v50, v50, v50 quad_perm:[1,0,3,2] row_mask:0xf bank_mask:0xf
  s_nop 1
  v_add_f32_dpp v50, v50, v50 quad_perm:[2,3,0,1] row_mask:0xf bank_mask:0xf
  v_cvt_pk_bf16_f32 v50, v50, v50
  v_lshlrev_b32 v50, 16, v50
  v_mul_f32 v50, s67, v50
  v_cvt_pk_bf16_f32 v50, v50, v50
  v_lshlrev_b32 v50, 16, v50
  v_max_f32 v22, v22, v50
  v_dot2_f32_bf16 v16, v112, v12, 0
  v_dot2_f32_bf16 v16, v113, v13, v16
  v_dot2_f32_bf16 v16, v114, v14, v16
  v_dot2_f32_bf16 v16, v115, v15, v16
  v_dot2_f32_bf16 v17, v116, v12, 0
  v_dot2_f32_bf16 v17, v117, v13, v17
  v_dot2_f32_bf16 v17, v118, v14, v17
  v_dot2_f32_bf16 v17, v119, v15, v17
  s_xor_b32 s60, s97, 0xa2c00
  s_bitcmp1_b32 s64, 20
  s_waitcnt vmcnt(6)
  s_cbranch_scc1 L_w51
  s_bitcmp0_b32 s65, 20
  s_waitcnt vmcnt(4)
  s_cbranch_scc1 L_w51
  s_waitcnt vmcnt(3)
L_w51:
  buffer_load_dwordx4 v[84:87], v8, s[40:43], s60 offen nt
  v_dot2_f32_bf16 v18, v120, v12, 0
  v_dot2_f32_bf16 v18, v121, v13, v18
  v_dot2_f32_bf16 v18, v122, v14, v18
  v_dot2_f32_bf16 v18, v123, v15, v18
  v_dot2_f32_bf16 v19, v124, v12, 0
  v_dot2_f32_bf16 v19, v125, v13, v19
  v_dot2_f32_bf16 v19, v126, v14, v19
  v_dot2_f32_bf16 v19, v127, v15, v19
  v_add_f32_dpp v20, v16, v16 row_ror:8 row_mask:0xf bank_mask:0x3
  v_add_f32_dpp v21, v17, v17 row_ror:8 row_mask:0xf bank_mask:0x3
  v_add_f32_dpp v20, v18, v18 row_ror:8 row_mask:0xf bank_mask:0xc
  v_add_f32_dpp v21, v19, v19 row_ror:8 row_mask:0xf bank_mask:0xc
  s_nop 0
  v_add_f32_dpp v51, v20, v20 row_shl:4 row_mask:0xf bank_mask:0x5
  v_add_f32_dpp v51, v21, v21 row_shr:4 row_mask:0xf bank_mask:0xa
  s_nop 1
  v_add_f32_dpp v51, v51, v51 quad_perm:[1,0,3,2] row_mask:0xf bank_mask:0xf
  s_nop 1
  v_add_f32_dpp v51, v51, v51 quad_perm:[2,3,0,1] row_mask:0xf bank_mask:0xf
  v_cvt_pk_bf16_f32 v51, v51, v51
  v_lshlrev_b32 v51, 16, v51
  v_mul_f32 v51, s67, v51
  v_cvt_pk_bf16_f32 v51, v51, v51
  v_lshlrev_b32 v51, 16, v51
  v_max_f32 v22, v22, v51
  s_xor_b32 s60, s97, 0xbc000
  s_bitcmp1_b32 s64, 19
  s_waitcnt vmcnt(6)
  s_cbranch_scc1 L_w52
  s_bitcmp0_b32 s65, 19
  s_waitcnt vmcnt(4)
  s_cbranch_scc1 L_w52
  s_waitcnt vmcnt(3)
L_w52:
  buffer_load_dwordx4 v[88:91], v8, s[40:43], s60 offen nt
  v_dot2_f32_bf16 v16, v128, v12, 0
  v_dot2_f32_bf16 v16, v129, v13, v16
  v_dot2_f32_bf16 v16, v130, v14, v16
  v_dot2_f32_bf16 v16, v131, v15, v16
  v_dot2_f32_bf16 v17, v132, v12, 0
  v_dot2_f32_bf16 v17, v133, v13, v17
  v_dot2_f32_bf16 v17, v134, v14, v17
  v_dot2_f32_bf16 v17, v135, v15, v17
  v_dot2_f32_bf16 v18, v136, v12, 0
  v_dot2_f32_bf16 v18, v137, v13, v18
  v_dot2_f32_bf16 v18, v138, v14, v18
  v_dot2_f32_bf16 v18, v139, v15, v18
  v_dot2_f32_bf16 v19, v140, v12, 0
  v_dot2_f32_bf16 v19, v141, v13, v19
  v_dot2_f32_bf16 v19, v142, v14, v19
  v_dot2_f32_bf16 v19, v143, v15, v19
  s_xor_b32 s60, s97, 0xbe400
  s_bitcmp1_b32 s64, 18
  s_waitcnt vmcnt(6)
  s_cbranch_scc1 L_w53
  s_bitcmp0_b32 s65, 18
  s_waitcnt vmcnt(4)
  s_cbranch_scc1 L_w53
  s_waitcnt vmcnt(3)
L_w53:
  buffer_load_dwordx4 v[92:95], v8, s[40:43], s60 offen nt
  v_add_f32_dpp v20, v16, v16 row_ror:8 row_mask:0xf bank_mask:0x3
  v_add_f32_dpp v21, v17, v17 row_ror:8 row_mask:0xf bank_mask:0x3
  v_add_f32_dpp v20, v18, v18 row_ror:8 row_mask:0xf bank_mask:0xc
  v_add_f32_dpp v21, v19, v19 row_ror:8 row_mask:0xf bank_mask:0xc
  s_nop 0
  v_add_f32_dpp v52, v20, v20 row_shl:4 row_mask:0xf bank_mask:0x5
  v_add_f32_dpp v52, v21, v21 row_shr:4 row_mask:0xf bank_mask:0xa
  s_nop 1
  v_add_f32_dpp v52, v52, v52 quad_perm:[1,0,3,2] row_mask:0xf bank_mask:0xf
  s_nop 1
  v_add_f32_dpp v52, v52, v52 quad_perm:[2,3,0,1] row_mask:0xf bank_mask:0xf
  v_cvt_pk_bf16_f32 v52, v52, v52
  v_lshlrev_b32 v52, 16, v52
  v_mul_f32 v52, s67, v52
  v_cvt_pk_bf16_f32 v52, v52, v52
  v_lshlrev_b32 v52, 16, v52
  v_max_f32 v22, v22, v52
  v_dot2_f32_bf16 v16, v144, v12, 0
  v_dot2_f32_bf16 v16, v145, v13, v16
  v_dot2_f32_bf16 v16, v146, v14, v16
  v_dot2_f32_bf16 v16, v147, v15, v16
  v_dot2_f32_bf16 v17, v148, v12, 0
  v_dot2_f32_bf16 v17, v149, v13, v17
  v_dot2_f32_bf16 v17, v150, v14, v17
  v_dot2_f32_bf16 v17, v151, v15, v17
  s_xor_b32 s60, s97, 0xbcc00
  s_bitcmp1_b32 s64, 17
  s_waitcnt vmcnt(6)
  s_cbranch_scc1 L_w54
  s_bitcmp0_b32 s65, 17
  s_waitcnt vmcnt(4)
  s_cbranch_scc1 L_w54
  s_waitcnt vmcnt(3)
L_w54:
  buffer_load_dwordx4 v[96:99], v8, s[40:43], s60 offen nt
  v_dot2_f32_bf16 v18, v152, v12, 0
  v_dot2_f32_bf16 v18, v153, v13, v18
  v_dot2_f32_bf16 v18, v154, v14, v18
  v_dot2_f32_bf16 v18, v155, v15, v18
  v_dot2_f32_bf16 v19, v156, v12, 0
  v_dot2_f32_bf16 v19, v157, v13, v19
  v_dot2_f32_bf16 v19, v158, v14, v19
  v_dot2_f32_bf16 v19, v159, v15, v19
  v_add_f32_dpp v20, v16, v16 row_ror:8 row_mask:0xf bank_mask:0x3
  v_add_f32_dpp v21, v17, v17 row_ror:8 row_mask:0xf bank_mask:0x3
  v_add_f32_dpp v20, v18, v18 row_ror:8 row_mask:0xf bank_mask:0xc
  v_add_f32_dpp v21, v19, v19 row_ror:8 row_mask:0xf bank_mask:0xc
  s_nop 0
  v_add_f32_dpp v53, v20, v20 row_shl:4 row_mask:0xf bank_mask:0x5
  v_add_f32_dpp v53, v21, v21 row_shr:4 row_mask:0xf bank_mask:0xa
  s_nop 1
  v_add_f32_dpp v53, v53, v53 quad_perm:[1,0,3,2] row_mask:0xf bank_mask:0xf
  s_nop 1
  v_add_f32_dpp v53, v53, v53 quad_perm:[2,3,0,1] row_mask:0xf bank_mask:0xf
  v_cvt_pk_bf16_f32 v53, v53, v53
  v_lshlrev_b32 v53, 16, v53
  v_mul_f32 v53, s67, v53
  v_cvt_pk_bf16_f32 v53, v53, v53
  v_lshlrev_b32 v53, 16, v53
  v_max_f32 v22, v22, v53
  s_xor_b32 s60, s97, 0xbe800
  s_bitcmp1_b32 s64, 16
  s_waitcnt vmcnt(6)
  s_cbranch_scc1 L_w55
  s_bitcmp0_b32 s65, 16
  s_waitcnt vmcnt(4)
  s_cbranch_scc1 L_w55
  s_waitcnt vmcnt(3)
L_w55:
  buffer_load_dwordx4 v[100:103], v8, s[40:43], s60 offen nt
  v_dot2_f32_bf16 v16, v160, v12, 0
  v_dot2_f32_bf16 v16, v161, v13, v16
  v_dot2_f32_bf16 v16, v162, v14, v16
  v_dot2_f32_bf16 v16, v163, v15, v16
  v_dot2_f32_bf16 v17, v164, v12, 0
  v_dot2_f32_bf16 v17, v165, v13, v17
  v_dot2_f32_bf16 v17, v166, v14, v17
  v_dot2_f32_bf16 v17, v167, v15, v17
  v_dot2_f32_bf16 v18, v168, v12, 0
  v_dot2_f32_bf16 v18, v169, v13, v18
  v_dot2_f32_bf16 v18, v170, v14, v18
  v_dot2_f32_bf16 v18, v171, v15, v18
  v_dot2_f32_bf16 v19, v172, v12, 0
  v_dot2_f32_bf16 v19, v173, v13, v19
  v_dot2_f32_bf16 v19, v174, v14, v19
  v_dot2_f32_bf16 v19, v175, v15, v19
  s_xor_b32 s60, s97, 0xe0c00
  s_bitcmp1_b32 s64, 15
  s_waitcnt vmcnt(6)
  s_cbranch_scc1 L_w56
  s_bitcmp0_b32 s65, 15
  s_waitcnt vmcnt(4)
  s_cbranch_scc1 L_w56
  s_waitcnt vmcnt(3)
L_w56:
  buffer_load_dwordx4 v[104:107], v8, s[40:43], s60 offen nt
  v_add_f32_dpp v20, v16, v16 row_ror:8 row_mask:0xf bank_mask:0x3
  v_add_f32_dpp v21, v17, v17 row_ror:8 row_mask:0xf bank_mask:0x3
  v_add_f32_dpp v20, v18, v18 row_ror:8 row_mask:0xf bank_mask:0xc
  v_add_f32_dpp v21, v19, v19 row_ror:8 row_mask:0xf bank_mask:0xc
  s_nop 0
  v_add_f32_dpp v54, v20, v20 row_shl:4 row_mask:0xf bank_mask:0x5
  v_add_f32_dpp v54, v21, v21 row_shr:4 row_mask:0xf bank_mask:0xa
  s_nop 1
  v_add_f32_dpp v54, v54, v54 quad_perm:[1,0,3,2] row_mask:0xf bank_mask:0xf
  s_nop 1
  v_add_f32_dpp v54, v54, v54 quad_perm:[2,3,0,1] row_mask:0xf bank_mask:0xf
  v_cvt_pk_bf16_f32 v54, v54, v54
  v_lshlrev_b32 v54, 16, v54
  v_mul_f32 v54, s67, v54
  v_cvt_pk_bf16_f32 v54, v54, v54
  v_lshlrev_b32 v54, 16, v54
  v_max_f32 v22, v22, v54
  v_dot2_f32_bf16 v16, v176, v12, 0
  v_dot2_f32_bf16 v16, v177, v13, v16
  v_dot2_f32_bf16 v16, v178, v14, v16
  v_dot2_f32_bf16 v16, v179, v15, v16
  v_dot2_f32_bf16 v17, v180, v12, 0
  v_dot2_f32_bf16 v17, v181, v13, v17
  v_dot2_f32_bf16 v17, v182, v14, v17
  v_dot2_f32_bf16 v17, v183, v15, v17
  s_xor_b32 s60, s97, 0xe2800
  s_bitcmp1_b32 s64, 14
  s_waitcnt vmcnt(6)
  s_cbranch_scc1 L_w57
  s_bitcmp0_b32 s65, 14
  s_waitcnt vmcnt(4)
  s_cbranch_scc1 L_w57
  s_waitcnt vmcnt(3)
L_w57:
  buffer_load_dwordx4 v[108:111], v8, s[40:43], s60 offen nt
  v_dot2_f32_bf16 v18, v184, v12, 0
  v_dot2_f32_bf16 v18, v185, v13, v18
  v_dot2_f32_bf16 v18, v186, v14, v18
  v_dot2_f32_bf16 v18, v187, v15, v18
  v_dot2_f32_bf16 v19, v188, v12, 0
  v_dot2_f32_bf16 v19, v189, v13, v19
  v_dot2_f32_bf16 v19, v190, v14, v19
  v_dot2_f32_bf16 v19, v191, v15, v19
  v_add_f32_dpp v20, v16, v16 row_ror:8 row_mask:0xf bank_mask:0x3
  v_add_f32_dpp v21, v17, v17 row_ror:8 row_mask:0xf bank_mask:0x3
  v_add_f32_dpp v20, v18, v18 row_ror:8 row_mask:0xf bank_mask:0xc
  v_add_f32_dpp v21, v19, v19 row_ror:8 row_mask:0xf bank_mask:0xc
  s_nop 0
  v_add_f32_dpp v55, v20, v20 row_shl:4 row_mask:0xf bank_mask:0x5
  v_add_f32_dpp v55, v21, v21 row_shr:4 row_mask:0xf bank_mask:0xa
  s_nop 1
  v_add_f32_dpp v55, v55, v55 quad_perm:[1,0,3,2] row_mask:0xf bank_mask:0xf
  s_nop 1
  v_add_f32_dpp v55, v55, v55 quad_perm:[2,3,0,1] row_mask:0xf bank_mask:0xf
  v_cvt_pk_bf16_f32 v55, v55, v55
  v_lshlrev_b32 v55, 16, v55
  v_mul_f32 v55, s67, v55
  v_cvt_pk_bf16_f32 v55, v55, v55
  v_lshlrev_b32 v55, 16, v55
  v_max_f32 v22, v22, v55
  s_xor_b32 s60, s97, 0xe0000
  s_bitcmp1_b32 s64, 13
  s_waitcnt vmcnt(6)
  s_cbranch_scc1 L_w58
  s_bitcmp0_b32 s65, 13
  s_waitcnt vmcnt(4)
  s_cbranch_scc1 L_w58
  s_waitcnt vmcnt(3)
L_w58:
  buffer_load_dwordx4 v[112:115], v8, s[40:43], s60 offen nt
  v_dot2_f32_bf16 v16, v192, v12, 0
  v_dot2_f32_bf16 v16, v193, v13, v16
  v_dot2_f32_bf16 v16, v194, v14, v16
  v_dot2_f32_bf16 v16, v195, v15, v16
  v_dot2_f32_bf16 v17, v196, v12, 0
  v_dot2_f32_bf16 v17, v197, v13, v17
  v_dot2_f32_bf16 v17, v198, v14, v17
  v_dot2_f32_bf16 v17, v199, v15, v17
  v_dot2_f32_bf16 v18, v200, v12, 0
  v_dot2_f32_bf16 v18, v201, v13, v18
  v_dot2_f32_bf16 v18, v202, v14, v18
  v_dot2_f32_bf16 v18, v203, v15, v18
  v_dot2_f32_bf16 v19, v204, v12, 0
  v_dot2_f32_bf16 v19, v205, v13, v19
  v_dot2_f32_bf16 v19, v206, v14, v19
  v_dot2_f32_bf16 v19, v207, v15, v19
  s_xor_b32 s60, s97, 0xe2400
  s_bitcmp1_b32 s64, 12
  s_waitcnt vmcnt(6)
  s_cbranch_scc1 L_w59
  s_bitcmp0_b32 s65, 12
  s_waitcnt vmcnt(4)
  s_cbranch_scc1 L_w59
  s_waitcnt vmcnt(3)
L_w59:
  buffer_load_dwordx4 v[116:119], v8, s[40:43], s60 offen nt
  v_add_f32_dpp v20, v16, v16 row_ror:8 row_mask:0xf bank_mask:0x3
  v_add_f32_dpp v21, v17, v17 row_ror:8 row_mask:0xf bank_mask:0x3
  v_add_f32_dpp v20, v18, v18 row_ror:8 row_mask:0xf bank_mask:0xc
  v_add_f32_dpp v21, v19, v19 row_ror:8 row_mask:0xf bank_mask:0xc
  s_nop 0
  v_add_f32_dpp v56, v20, v20 row_shl:4 row_mask:0xf bank_mask:0x5
  v_add_f32_dpp v56, v21, v21 row_shr:4 row_mask:0xf bank_mask:0xa
  s_nop 1
  v_add_f32_dpp v56, v56, v56 quad_perm:[1,0,3,2] row_mask:0xf bank_mask:0xf
  s_nop 1
  v_add_f32_dpp v56, v56, v56 quad_perm:[2,3,0,1] row_mask:0xf bank_mask:0xf
  v_cvt_pk_bf16_f32 v56, v56, v56
  v_lshlrev_b32 v56, 16, v56
  v_mul_f32 v56, s67, v56
  v_cvt_pk_bf16_f32 v56, v56, v56
  v_lshlrev_b32 v56, 16, v56
  v_max_f32 v22, v22, v56
  v_dot2_f32_bf16 v16, v208, v12, 0
  v_dot2_f32_bf16 v16, v209, v13, v16
  v_dot2_f32_bf16 v16, v210, v14, v16
  v_dot2_f32_bf16 v16, v211, v15, v16
  v_dot2_f32_bf16 v17, v212, v12, 0
  v_dot2_f32_bf16 v17, v213, v13, v17
  v_dot2_f32_bf16 v17, v214, v14, v17
  v_dot2_f32_bf16 v17, v215, v15, v17
  s_xor_b32 s60, s97, 0xfc800
  s_bitcmp1_b32 s64, 11
  s_waitcnt vmcnt(6)
  s_cbranch_scc1 L_w60
  s_bitcmp0_b32 s65, 11
  s_waitcnt vmcnt(4)
  s_cbranch_scc1 L_w60
  s_waitcnt vmcnt(3)
L_w60:
  buffer_load_dwordx4 v[120:123], v8, s[40:43], s60 offen nt
  v_dot2_f32_bf16 v18, v216, v12, 0
  v_dot2_f32_bf16 v18, v217, v13, v18
  v_dot2_f32_bf16 v18, v218, v14, v18
  v_dot2_f32_bf16 v18, v219, v15, v18
  v_dot2_f32_bf16 v19, v220, v12, 0
  v_dot2_f32_bf16 v19, v221, v13, v19
  v_dot2_f32_bf16 v19, v222, v14, v19
  v_dot2_f32_bf16 v19, v223, v15, v19
  v_add_f32_dpp v20, v16, v16 row_ror:8 row_mask:0xf bank_mask:0x3
  v_add_f32_dpp v21, v17, v17 row_ror:8 row_mask:0xf bank_mask:0x3
  v_add_f32_dpp v20, v18, v18 row_ror:8 row_mask:0xf bank_mask:0xc
  v_add_f32_dpp v21, v19, v19 row_ror:8 row_mask:0xf bank_mask:0xc
  s_nop 0
  v_add_f32_dpp v57, v20, v20 row_shl:4 row_mask:0xf bank_mask:0x5
  v_add_f32_dpp v57, v21, v21 row_shr:4 row_mask:0xf bank_mask:0xa
  s_nop 1
  v_add_f32_dpp v57, v57, v57 quad_perm:[1,0,3,2] row_mask:0xf bank_mask:0xf
  s_nop 1
  v_add_f32_dpp v57, v57, v57 quad_perm:[2,3,0,1] row_mask:0xf bank_mask:0xf
  v_cvt_pk_bf16_f32 v57, v57, v57
  v_lshlrev_b32 v57, 16, v57
  v_mul_f32 v57, s67, v57
  v_cvt_pk_bf16_f32 v57, v57, v57
  v_lshlrev_b32 v57, 16, v57
  v_max_f32 v22, v22, v57
  s_xor_b32 s60, s97, 0xfec00
  s_bitcmp1_b32 s64, 10
  s_waitcnt vmcnt(6)
  s_cbranch_scc1 L_w61
  s_bitcmp0_b32 s65, 10
  s_waitcnt vmcnt(4)
  s_cbranch_scc1 L_w61
  s_waitcnt vmcnt(3)
L_w61:
  buffer_load_dwordx4 v[124:127], v8, s[40:43], s60 offen nt
  v_dot2_f32_bf16 v16, v224, v12, 0
  v_dot2_f32_bf16 v16, v225, v13, v16
  v_dot2_f32_bf16 v16, v226, v14, v16
  v_dot2_f32_bf16 v16, v227, v15, v16
  v_dot2_f32_bf16 v17, v228, v12, 0
  v_dot2_f32_bf16 v17, v229, v13, v17
  v_dot2_f32_bf16 v17, v230, v14, v17
  v_dot2_f32_bf16 v17, v231, v15, v17
  v_dot2_f32_bf16 v18, v232, v12, 0
  v_dot2_f32_bf16 v18, v233, v13, v18
  v_dot2_f32_bf16 v18, v234, v14, v18
  v_dot2_f32_bf16 v18, v235, v15, v18
  v_dot2_f32_bf16 v19, v236, v12, 0
  v_dot2_f32_bf16 v19, v237, v13, v19
  v_dot2_f32_bf16 v19, v238, v14, v19
  v_dot2_f32_bf16 v19, v239, v15, v19
  s_xor_b32 s60, s97, 0xfc400
  s_bitcmp1_b32 s64, 9
  s_waitcnt vmcnt(6)
  s_cbranch_scc1 L_w62
  s_bitcmp0_b32 s65, 9
  s_waitcnt vmcnt(4)
  s_cbranch_scc1 L_w62
  s_waitcnt vmcnt(3)
L_w62:
  buffer_load_dwordx4 v[128:131], v8, s[40:43], s60 offen nt
  s_mov_b64 exec, 1
  ds_add_u32 v26, v27 offset:160
  s_mov_b64 exec, -1
  v_add_f32_dpp v20, v16, v16 row_ror:8 row_mask:0xf bank_mask:0x3
  v_add_f32_dpp v21, v17, v17 row_ror:8 row_mask:0xf bank_mask:0x3
  v_add_f32_dpp v20, v18, v18 row_ror:8 row_mask:0xf bank_mask:0xc
  v_add_f32_dpp v21, v19, v19 row_ror:8 row_mask:0xf bank_mask:0xc
  s_nop 0
  v_add_f32_dpp v58, v20, v20 row_shl:4 row_mask:0xf bank_mask:0x5
  v_add_f32_dpp v58, v21, v21 row_shr:4 row_mask:0xf bank_mask:0xa
  s_nop 1
  v_add_f32_dpp v58, v58, v58 quad_perm:[1,0,3,2] row_mask:0xf bank_mask:0xf
  s_nop 1
  v_add_f32_dpp v58, v58, v58 quad_perm:[2,3,0,1] row_mask:0xf bank_mask:0xf
  v_cvt_pk_bf16_f32 v58, v58, v58
  v_lshlrev_b32 v58, 16, v58
  v_mul_f32 v58, s67, v58
  v_cvt_pk_bf16_f32 v58, v58, v58
  v_lshlrev_b32 v58, 16, v58
  v_max_f32 v22, v22, v58
  v_dot2_f32_bf16 v16, v240, v12, 0
  v_dot2_f32_bf16 v16, v241, v13, v16
  v_dot2_f32_bf16 v16, v242, v14, v16
  v_dot2_f32_bf16 v16, v243, v15, v16
  s_xor_b32 s60, s97, 0xfe000
  s_bitcmp1_b32 s64, 8
  s_waitcnt vmcnt(6)
  s_cbranch_scc1 L_w63
  s_bitcmp0_b32 s65, 8
  s_waitcnt vmcnt(4)
  s_cbranch_scc1 L_w63
  s_waitcnt vmcnt(3)
L_w63:
  buffer_load_dwordx4 v[132:135], v8, s[40:43], s60 offen nt
  v_dot2_f32_bf16 v17, v244, v12, 0
  v_dot2_f32_bf16 v17, v245, v13, v17
  v_dot2_f32_bf16 v17, v246, v14, v17
  v_dot2_f32_bf16 v17, v247, v15, v17
  v_dot2_f32_bf16 v18, v64, v12, 0
  v_dot2_f32_bf16 v18, v65, v13, v18
  v_dot2_f32_bf16 v18, v66, v14, v18
  v_dot2_f32_bf16 v18, v67, v15, v18
  v_dot2_f32_bf16 v19, v68, v12, 0
  v_dot2_f32_bf16 v19, v69, v13, v19
  v_dot2_f32_bf16 v19, v70, v14, v19
  v_dot2_f32_bf16 v19, v71, v15, v19
  s_xor_b32 s60, s97, 0x0
  s_bitcmp1_b32 s64, 7
  s_waitcnt vmcnt(6)
  s_cbranch_scc1 L_w64
  s_bitcmp0_b32 s65, 7
  s_waitcnt vmcnt(4)
  s_cbranch_scc1 L_w64
  s_waitcnt vmcnt(3)
L_w64:
  buffer_load_dwordx4 v[136:139], v8, s[44:47], s60 offen nt
  v_add_f32_dpp v20, v16, v16 row_ror:8 row_mask:0xf bank_mask:0x3
  v_add_f32_dpp v21, v17, v17 row_ror:8 row_mask:0xf bank_mask:0x3
  v_add_f32_dpp v20, v18, v18 row_ror:8 row_mask:0xf bank_mask:0xc
  v_add_f32_dpp v21, v19, v19 row_ror:8 row_mask:0xf bank_mask:0xc
  s_nop 0
  v_add_f32_dpp v59, v20, v20 row_shl:4 row_mask:0xf bank_mask:0x5
  v_add_f32_dpp v59, v21, v21 row_shr:4 row_mask:0xf bank_mask:0xa
  s_nop 1
  v_add_f32_dpp v59, v59, v59 quad_perm:[1,0,3,2] row_mask:0xf bank_mask:0xf
  s_nop 1
  v_add_f32_dpp v59, v59, v59 quad_perm:[2,3,0,1] row_mask:0xf bank_mask:0xf
  v_cvt_pk_bf16_f32 v59, v59, v59
  v_lshlrev_b32 v59, 16, v59
  v_mul_f32 v59, s67, v59
  v_cvt_pk_bf16_f32 v59, v59, v59
  v_lshlrev_b32 v59, 16, v59
  v_max_f32 v22, v22, v59
  v_dot2_f32_bf16 v16, v72, v12, 0
  v_dot2_f32_bf16 v16, v73, v13, v16
  v_dot2_f32_bf16 v16, v74, v14, v16
  v_dot2_f32_bf16 v16, v75, v15, v16
  v_dot2_f32_bf16 v17, v76, v12, 0
  v_dot2_f32_bf16 v17, v77, v13, v17
  v_dot2_f32_bf16 v17, v78, v14, v17
  v_dot2_f32_bf16 v17, v79, v15, v17
  s_xor_b32 s60, s97, 0x2400
  s_bitcmp1_b32 s64, 6
  s_waitcnt vmcnt(6)
  s_cbranch_scc1 L_w65
  s_bitcmp0_b32 s65, 6
  s_waitcnt vmcnt(4)
  s_cbranch_scc1 L_w65
  s_waitcnt vmcnt(3)
L_w65:
  buffer_load_dwordx4 v[140:143], v8, s[44:47], s60 offen nt
  v_dot2_f32_bf16 v18, v80, v12, 0
  v_dot2_f32_bf16 v18, v81, v13, v18
  v_dot2_f32_bf16 v18, v82, v14, v18
  v_dot2_f32_bf16 v18, v83, v15, v18
  v_dot2_f32_bf16 v19, v84, v12, 0
  v_dot2_f32_bf16 v19, v85, v13, v19
  v_dot2_f32_bf16 v19, v86, v14, v19
  v_dot2_f32_bf16 v19, v87, v15, v19
  v_add_f32_dpp v20, v16, v16 row_ror:8 row_mask:0xf bank_mask:0x3
  v_add_f32_dpp v21, v17, v17 row_ror:8 row_mask:0xf bank_mask:0x3
  v_add_f32_dpp v20, v18, v18 row_ror:8 row_mask:0xf bank_mask:0xc
  v_add_f32_dpp v21, v19, v19 row_ror:8 row_mask:0xf bank_mask:0xc
  s_nop 0
  v_add_f32_dpp v60, v20, v20 row_shl:4 row_mask:0xf bank_mask:0x5
  v_add_f32_dpp v60, v21, v21 row_shr:4 row_mask:0xf bank_mask:0xa
  s_nop 1
  v_add_f32_dpp v60, v60, v60 quad_perm:[1,0,3,2] row_mask:0xf bank_mask:0xf
  s_nop 1
  v_add_f32_dpp v60, v60, v60 quad_perm:[2,3,0,1] row_mask:0xf bank_mask:0xf
  v_cvt_pk_bf16_f32 v60, v60, v60
  v_lshlrev_b32 v60, 16, v60
  v_mul_f32 v60, s67, v60
  v_cvt_pk_bf16_f32 v60, v60, v60
  v_lshlrev_b32 v60, 16, v60
  v_max_f32 v22, v22, v60
  s_xor_b32 s60, s97, 0xc00
  s_bitcmp1_b32 s64, 5
  s_waitcnt vmcnt(6)
  s_cbranch_scc1 L_w66
  s_bitcmp0_b32 s65, 5
  s_waitcnt vmcnt(4)
  s_cbranch_scc1 L_w66
  s_waitcnt vmcnt(3)
L_w66:
  buffer_load_dwordx4 v[144:147], v8, s[44:47], s60 offen nt
  v_dot2_f32_bf16 v16, v88, v12, 0
  v_dot2_f32_bf16 v16, v89, v13, v16
  v_dot2_f32_bf16 v16, v90, v14, v16
  v_dot2_f32_bf16 v16, v91, v15, v16
  v_dot2_f32_bf16 v17, v92, v12, 0
  v_dot2_f32_bf16 v17, v93, v13, v17
  v_dot2_f32_bf16 v17, v94, v14, v17
  v_dot2_f32_bf16 v17, v95, v15, v17
  v_dot2_f32_bf16 v18, v96, v12, 0
  v_dot2_f32_bf16 v18, v97, v13, v18
  v_dot2_f32_bf16 v18, v98, v14, v18
  v_dot2_f32_bf16 v18, v99, v15, v18
  v_dot2_f32_bf16 v19, v100, v12, 0
  v_dot2_f32_bf16 v19, v101, v13, v19
  v_dot2_f32_bf16 v19, v102, v14, v19
  v_dot2_f32_bf16 v19, v103, v15, v19
  s_xor_b32 s60, s97, 0x2800
  s_bitcmp1_b32 s64, 4
  s_waitcnt vmcnt(6)
  s_cbranch_scc1 L_w67
  s_bitcmp0_b32 s65, 4
  s_waitcnt vmcnt(4)
  s_cbranch_scc1 L_w67
  s_waitcnt vmcnt(3)
L_w67:
  buffer_load_dwordx4 v[148:151], v8, s[44:47], s60 offen nt
  v_add_f32_dpp v20, v16, v16 row_ror:8 row_mask:0xf bank_mask:0x3
  v_add_f32_dpp v21, v17, v17 row_ror:8 row_mask:0xf bank_mask:0x3
  v_add_f32_dpp v20, v18, v18 row_ror:8 row_mask:0xf bank_mask:0xc
  v_add_f32_dpp v21, v19, v19 row_ror:8 row_mask:0xf bank_mask:0xc
  s_nop 0
  v_add_f32_dpp v61, v20, v20 row_shl:4 row_mask:0xf bank_mask:0x5
  v_add_f32_dpp v61, v21, v21 row_shr:4 row_mask:0xf bank_mask:0xa
  s_nop 1
  v_add_f32_dpp v61, v61, v61 quad_perm:[1,0,3,2] row_mask:0xf bank_mask:0xf
  s_nop 1
  v_add_f32_dpp v61, v61, v61 quad_perm:[2,3,0,1] row_mask:0xf bank_mask:0xf
  v_cvt_pk_bf16_f32 v61, v61, v61
  v_lshlrev_b32 v61, 16, v61
  v_mul_f32 v61, s67, v61
  v_cvt_pk_bf16_f32 v61, v61, v61
  v_lshlrev_b32 v61, 16, v61
  v_max_f32 v22, v22, v61
  v_dot2_f32_bf16 v16, v104, v12, 0
  v_dot2_f32_bf16 v16, v105, v13, v16
  v_dot2_f32_bf16 v16, v106, v14, v16
  v_dot2_f32_bf16 v16, v107, v15, v16
  v_dot2_f32_bf16 v17, v108, v12, 0
  v_dot2_f32_bf16 v17, v109, v13, v17
  v_dot2_f32_bf16 v17, v110, v14, v17
  v_dot2_f32_bf16 v17, v111, v15, v17
  s_xor_b32 s60, s97, 0x1c400
  s_bitcmp1_b32 s64, 3
  s_waitcnt vmcnt(6)
  s_cbranch_scc1 L_w68
  s_bitcmp0_b32 s65, 3
  s_waitcnt vmcnt(4)
  s_cbranch_scc1 L_w68
  s_waitcnt vmcnt(3)
L_w68:
  buffer_load_dwordx4 v[152:155], v8, s[44:47], s60 offen nt
  v_dot2_f32_bf16 v18, v112, v12, 0
  v_dot2_f32_bf16 v18, v113, v13, v18
  v_dot2_f32_bf16 v18, v114, v14, v18
  v_dot2_f32_bf16 v18, v115, v15, v18
  v_dot2_f32_bf16 v19, v116, v12, 0
  v_dot2_f32_bf16 v19, v117, v13, v19
  v_dot2_f32_bf16 v19, v118, v14, v19
  v_dot2_f32_bf16 v19, v119, v15, v19
  v_add_f32_dpp v20, v16, v16 row_ror:8 row_mask:0xf bank_mask:0x3
  v_add_f32_dpp v21, v17, v17 row_ror:8 row_mask:0xf bank_mask:0x3
  v_add_f32_dpp v20, v18, v18 row_ror:8 row_mask:0xf bank_mask:0xc
  v_add_f32_dpp v21, v19, v19 row_ror:8 row_mask:0xf bank_mask:0xc
  s_nop 0
  v_add_f32_dpp v62, v20, v20 row_shl:4 row_mask:0xf bank_mask:0x5
  v_add_f32_dpp v62, v21, v21 row_shr:4 row_mask:0xf bank_mask:0xa
  s_nop 1
  v_add_f32_dpp v62, v62, v62 quad_perm:[1,0,3,2] row_mask:0xf bank_mask:0xf
  s_nop 1
  v_add_f32_dpp v62, v62, v62 quad_perm:[2,3,0,1] row_mask:0xf bank_mask:0xf
  v_cvt_pk_bf16_f32 v62, v62, v62
  v_lshlrev_b32 v62, 16, v62
  v_mul_f32 v62, s67, v62
  v_cvt_pk_bf16_f32 v62, v62, v62
  v_lshlrev_b32 v62, 16, v62
  v_max_f32 v22, v22, v62
  s_xor_b32 s60, s97, 0x1e000
  s_bitcmp1_b32 s64, 2
  s_waitcnt vmcnt(6)
  s_cbranch_scc1 L_w69
  s_bitcmp0_b32 s65, 2
  s_waitcnt vmcnt(4)
  s_cbranch_scc1 L_w69
  s_waitcnt vmcnt(3)
L_w69:
  buffer_load_dwordx4 v[156:159], v8, s[44:47], s60 offen nt
  v_dot2_f32_bf16 v16, v120, v12, 0
  v_dot2_f32_bf16 v16, v121, v13, v16
  v_dot2_f32_bf16 v16, v122, v14, v16
  v_dot2_f32_bf16 v16, v123, v15, v16
  v_dot2_f32_bf16 v17, v124, v12, 0
  v_dot2_f32_bf16 v17, v125, v13, v17
  v_dot2_f32_bf16 v17, v126, v14, v17
  v_dot2_f32_bf16 v17, v127, v15, v17
  v_dot2_f32_bf16 v18, v128, v12, 0
  v_dot2_f32_bf16 v18, v129, v13, v18
  v_dot2_f32_bf16 v18, v130, v14, v18
  v_dot2_f32_bf16 v18, v131, v15, v18
  s_xor_b32 s60, s97, 0x1c800
  s_bitcmp1_b32 s64, 1
  s_waitcnt vmcnt(6)
  s_cbranch_scc1 L_w70
  s_bitcmp0_b32 s65, 1
  s_waitcnt vmcnt(4)
  s_cbranch_scc1 L_w70
  s_waitcnt vmcnt(3)
L_w70:
  buffer_load_dwordx4 v[160:163], v8, s[44:47], s60 offen nt
  v_dot2_f32_bf16 v19, v132, v12, 0
  v_dot2_f32_bf16 v19, v133, v13, v19
  v_dot2_f32_bf16 v19, v134, v14, v19
  v_dot2_f32_bf16 v19, v135, v15, v19
  v_add_f32_dpp v20, v16, v16 row_ror:8 row_mask:0xf bank_mask:0x3
  v_add_f32_dpp v21, v17, v17 row_ror:8 row_mask:0xf bank_mask:0x3
  v_add_f32_dpp v20, v18, v18 row_ror:8 row_mask:0xf bank_mask:0xc
  v_add_f32_dpp v21, v19, v19 row_ror:8 row_mask:0xf bank_mask:0xc
  s_nop 0
  v_add_f32_dpp v63, v20, v20 row_shl:4 row_mask:0xf bank_mask:0x5
  v_add_f32_dpp v63, v21, v21 row_shr:4 row_mask:0xf bank_mask:0xa
  s_nop 1
  v_add_f32_dpp v63, v63, v63 quad_perm:[1,0,3,2] row_mask:0xf bank_mask:0xf
  s_nop 1
  v_add_f32_dpp v63, v63, v63 quad_perm:[2,3,0,1] row_mask:0xf bank_mask:0xf
  v_cvt_pk_bf16_f32 v63, v63, v63
  v_lshlrev_b32 v63, 16, v63
  v_mul_f32 v63, s67, v63
  v_cvt_pk_bf16_f32 v63, v63, v63
  v_lshlrev_b32 v63, 16, v63
  v_max_f32 v22, v22, v63
  ds_read2_b32 v[44:45], v26 offset0:44 offset1:52
  s_xor_b32 s60, s97, 0x1ec00
  s_bitcmp1_b32 s64, 0
  s_waitcnt vmcnt(6)
  s_cbranch_scc1 L_w71
  s_bitcmp0_b32 s65, 0
  s_waitcnt vmcnt(4)
  s_cbranch_scc1 L_w71
  s_waitcnt vmcnt(3)
L_w71:
  buffer_load_dwordx4 v[164:167], v8, s[44:47], s60 offen nt
  s_waitcnt lgkmcnt(0)
  v_readfirstlane_b32 s64, v44
  v_readfirstlane_b32 s65, v45
  s_nop 1
  v_max_f32_dpp v22, v22, v22 row_ror:4 row_mask:0xf bank_mask:0xf
  s_nop 1
  v_max_f32_dpp v22, v22, v22 row_ror:8 row_mask:0xf bank_mask:0xf
  v_mov_b32 v24, v22
  s_nop 1
  v_permlane16_swap_b32 v22, v24
  v_max_f32 v22, v22, v24
  v_mov_b32 v24, v22
  s_nop 1
  v_permlane32_swap_b32 v22, v24
  v_max_f32 v22, v22, v24
  v_mul_f32 v22, s66, v22
  v_mov_b32 v23, 0
  s_xor_b32 s60, s97, 0x40800
  s_bitcmp1_b32 s64, 27
  s_waitcnt vmcnt(6)
  s_cbranch_scc1 L_w72
  s_bitcmp0_b32 s65, 27
  s_waitcnt vmcnt(4)
  s_cbranch_scc1 L_w72
  s_waitcnt vmcnt(3)
L_w72:
  buffer_load_dwordx4 v[168:171], v8, s[44:47], s60 offen nt
  v_fma_f32 v48, v48, s66, -v22
  v_fma_f32 v49, v49, s66, -v22
  v_fma_f32 v50, v50, s66, -v22
  v_fma_f32 v51, v51, s66, -v22
  v_exp_f32 v48, v48
  v_exp_f32 v49, v49
  v_exp_f32 v50, v50
  v_exp_f32 v51, v51
  v_add_f32 v23, v23, v48
  v_cvt_pk_bf16_f32 v48, v48, v48
  v_add_f32 v23, v23, v49
  v_cvt_pk_bf16_f32 v49, v49, v49
  v_add_f32 v23, v23, v50
  v_cvt_pk_bf16_f32 v50, v50, v50
  v_add_f32 v23, v23, v51
  v_cvt_pk_bf16_f32 v51, v51, v51
  s_xor_b32 s60, s97, 0x42c00
  s_bitcmp1_b32 s64, 26
  s_waitcnt vmcnt(6)
  s_cbranch_scc1 L_w73
  s_bitcmp0_b32 s65, 26
  s_waitcnt vmcnt(4)
  s_cbranch_scc1 L_w73
  s_waitcnt vmcnt(3)
L_w73:
  buffer_load_dwordx4 v[172:175], v8, s[44:47], s60 offen nt
  v_fma_f32 v52, v52, s66, -v22
  v_fma_f32 v53, v53, s66, -v22
  v_fma_f32 v54, v54, s66, -v22
  v_fma_f32 v55, v55, s66, -v22
  v_exp_f32 v52, v52
  v_exp_f32 v53, v53
  v_exp_f32 v54, v54
  v_exp_f32 v55, v55
  v_add_f32 v23, v23, v52
  v_cvt_pk_bf16_f32 v52, v52, v52
  v_add_f32 v23, v23, v53
  v_cvt_pk_bf16_f32 v53, v53, v53
  v_add_f32 v23, v23, v54
  v_cvt_pk_bf16_f32 v54, v54, v54
  v_add_f32 v23, v23, v55
  v_cvt_pk_bf16_f32 v55, v55, v55
  s_xor_b32 s60, s97, 0x40400
  s_bitcmp1_b32 s64, 25
  s_waitcnt vmcnt(6)
  s_cbranch_scc1 L_w74
  s_bitcmp0_b32 s65, 25
  s_waitcnt vmcnt(4)
  s_cbranch_scc1 L_w74
  s_waitcnt vmcnt(3)
L_w74:
  buffer_load_dwordx4 v[176:179], v8, s[44:47], s60 offen nt
  v_fma_f32 v56, v56, s66, -v22
  v_fma_f32 v57, v57, s66, -v22
  v_fma_f32 v58, v58, s66, -v22
  v_fma_f32 v59, v59, s66, -v22
  v_exp_f32 v56, v56
  v_exp_f32 v57, v57
  v_exp_f32 v58, v58
  v_exp_f32 v59, v59
  v_add_f32 v23, v23, v56
  v_cvt_pk_bf16_f32 v56, v56, v56
  v_add_f32 v23, v23, v57
  v_cvt_pk_bf16_f32 v57, v57, v57
  v_add_f32 v23, v23, v58
  v_cvt_pk_bf16_f32 v58, v58, v58
  v_add_f32 v23, v23, v59
  v_cvt_pk_bf16_f32 v59, v59, v59
  ds_read2_b32 v[44:45], v26 offset0:44 offset1:52
  s_xor_b32 s60, s97, 0x42000
  s_bitcmp1_b32 s64, 24
  s_waitcnt vmcnt(6)
  s_cbranch_scc1 L_w75
  s_bitcmp0_b32 s65, 24
  s_waitcnt vmcnt(4)
  s_cbranch_scc1 L_w75
  s_waitcnt vmcnt(3)
L_w75:
  buffer_load_dwordx4 v[180:183], v8, s[44:47], s60 offen nt
  s_waitcnt lgkmcnt(0)
  v_readfirstlane_b32 s64, v44
  v_readfirstlane_b32 s65, v45
  v_fma_f32 v60, v60, s66, -v22
  v_fma_f32 v61, v61, s66, -v22
  v_fma_f32 v62, v62, s66, -v22
  v_fma_f32 v63, v63, s66, -v22
  v_exp_f32 v60, v60
  v_exp_f32 v61, v61
  v_exp_f32 v62, v62
  v_exp_f32 v63, v63
  v_add_f32 v23, v23, v60
  v_cvt_pk_bf16_f32 v60, v60, v60
  v_add_f32 v23, v23, v61
  v_cvt_pk_bf16_f32 v61, v61, v61
  v_add_f32 v23, v23, v62
  v_cvt_pk_bf16_f32 v62, v62, v62
  v_add_f32 v23, v23, v63
  v_cvt_pk_bf16_f32 v63, v63, v63
  s_xor_b32 s60, s97, 0x5cc00
  s_bitcmp1_b32 s64, 23
  s_waitcnt vmcnt(6)
  s_cbranch_scc1 L_w76
  s_bitcmp0_b32 s65, 23
  s_waitcnt vmcnt(4)
  s_cbranch_scc1 L_w76
  s_waitcnt vmcnt(3)
L_w76:
  buffer_load_dwordx4 v[184:187], v8, s[44:47], s60 offen nt
  s_nop 1
  v_add_f32_dpp v23, v23, v23 row_ror:4 row_mask:0xf bank_mask:0xf
  s_nop 1
  v_add_f32_dpp v23, v23, v23 row_ror:8 row_mask:0xf bank_mask:0xf
  v_mov_b32 v24, v23
  s_nop 1
  v_permlane16_swap_b32 v23, v24
  v_add_f32 v23, v23, v24
  v_mov_b32 v24, v23
  s_nop 1
  v_permlane32_swap_b32 v23, v24
  v_add_f32 v23, v23, v24
  s_lshl_b32 s36, s35, 3
  v_mov_b32 v24, s36
  s_mov_b64 exec, 1
  ds_write_b64 v24, v[22:23] offset:480
  ds_add_u32 v26, v27 offset:16
  s_mov_b64 exec, -1
  s_xor_b32 s60, s97, 0x5e800
  s_bitcmp1_b32 s64, 22
  s_waitcnt vmcnt(6)
  s_cbranch_scc1 L_w77
  s_bitcmp0_b32 s65, 22
  s_waitcnt vmcnt(4)
  s_cbranch_scc1 L_w77
  s_waitcnt vmcnt(3)
L_w77:
  buffer_load_dwordx4 v[188:191], v8, s[44:47], s60 offen nt
  v_and_b32_dpp v32, v48, v4 row_newbcast:0 row_mask:0xf bank_mask:0xf
  v_and_b32_dpp v33, v48, v5 row_newbcast:0 row_mask:0xf bank_mask:0xf
  v_and_b32_dpp v34, v48, v6 row_newbcast:0 row_mask:0xf bank_mask:0xf
  v_and_b32_dpp v35, v48, v7 row_newbcast:0 row_mask:0xf bank_mask:0xf
  s_nop 1
  v_mfma_f32_16x16x32_bf16 v[28:31], v[32:35], v[136:139], 0
  v_and_b32_dpp v36, v48, v4 row_newbcast:4 row_mask:0xf bank_mask:0xf
  v_and_b32_dpp v37, v48, v5 row_newbcast:4 row_mask:0xf bank_mask:0xf
  v_and_b32_dpp v38, v48, v6 row_newbcast:4 row_mask:0xf bank_mask:0xf
  v_and_b32_dpp v39, v48, v7 row_newbcast:4 row_mask:0xf bank_mask:0xf
  s_nop 1
  v_mfma_f32_16x16x32_bf16 v[28:31], v[36:39], v[140:143], v[28:31]
  v_and_b32_dpp v32, v48, v4 row_newbcast:8 row_mask:0xf bank_mask:0xf
  v_and_b32_dpp v33, v48, v5 row_newbcast:8 row_mask:0xf bank_mask:0xf
  v_and_b32_dpp v34, v48, v6 row_newbcast:8 row_mask:0xf bank_mask:0xf
  v_and_b32_dpp v35, v48, v7 row_newbcast:8 row_mask:0xf bank_mask:0xf
  s_nop 1
  v_mfma_f32_16x16x32_bf16 v[28:31], v[32:35], v[144:147], v[28:31]
  s_xor_b32 s60, s97, 0x5c000
  s_bitcmp1_b32 s64, 21
  s_waitcnt vmcnt(6)
  s_cbranch_scc1 L_w78
  s_bitcmp0_b32 s65, 21
  s_waitcnt vmcnt(4)
  s_cbranch_scc1 L_w78
  s_waitcnt vmcnt(3)
L_w78:
  buffer_load_dwordx4 v[192:195], v8, s[44:47], s60 offen nt
  v_and_b32_dpp v36, v48, v4 row_newbcast:12 row_mask:0xf bank_mask:0xf
  v_and_b32_dpp v37, v48, v5 row_newbcast:12 row_mask:0xf bank_mask:0xf
  v_and_b32_dpp v38, v48, v6 row_newbcast:12 row_mask:0xf bank_mask:0xf
  v_and_b32_dpp v39, v48, v7 row_newbcast:12 row_mask:0xf bank_mask:0xf
  s_nop 1
  v_mfma_f32_16x16x32_bf16 v[28:31], v[36:39], v[148:151], v[28:31]
  v_and_b32_dpp v32, v49, v4 row_newbcast:0 row_mask:0xf bank_mask:0xf
  v_and_b32_dpp v33, v49, v5 row_newbcast:0 row_mask:0xf bank_mask:0xf
  v_and_b32_dpp v34, v49, v6 row_newbcast:0 row_mask:0xf bank_mask:0xf
  v_and_b32_dpp v35, v49, v7 row_newbcast:0 row_mask:0xf bank_mask:0xf
  s_nop 1
  v_mfma_f32_16x16x32_bf16 v[28:31], v[32:35], v[152:155], v[28:31]
  v_and_b32_dpp v36, v49, v4 row_newbcast:4 row_mask:0xf bank_mask:0xf
  v_and_b32_dpp v37, v49, v5 row_newbcast:4 row_mask:0xf bank_mask:0xf
  v_and_b32_dpp v38, v49, v6 row_newbcast:4 row_mask:0xf bank_mask:0xf
  v_and_b32_dpp v39, v49, v7 row_newbcast:4 row_mask:0xf bank_mask:0xf
  s_nop 1
  v_mfma_f32_16x16x32_bf16 v[28:31], v[36:39], v[156:159], v[28:31]
  s_xor_b32 s60, s97, 0x5e400
  s_bitcmp1_b32 s64, 20
  s_waitcnt vmcnt(6)
  s_cbranch_scc1 L_w79
  s_bitcmp0_b32 s65, 20
  s_waitcnt vmcnt(4)
  s_cbranch_scc1 L_w79
  s_waitcnt vmcnt(3)
L_w79:
  buffer_load_dwordx4 v[196:199], v8, s[44:47], s60 offen nt
  v_and_b32_dpp v32, v49, v4 row_newbcast:8 row_mask:0xf bank_mask:0xf
  v_and_b32_dpp v33, v49, v5 row_newbcast:8 row_mask:0xf bank_mask:0xf
  v_and_b32_dpp v34, v49, v6 row_newbcast:8 row_mask:0xf bank_mask:0xf
  v_and_b32_dpp v35, v49, v7 row_newbcast:8 row_mask:0xf bank_mask:0xf
  s_nop 1
  v_mfma_f32_16x16x32_bf16 v[28:31], v[32:35], v[160:163], v[28:31]
  v_and_b32_dpp v36, v49, v4 row_newbcast:12 row_mask:0xf bank_mask:0xf
  v_and_b32_dpp v37, v49, v5 row_newbcast:12 row_mask:0xf bank_mask:0xf
  v_and_b32_dpp v38, v49, v6 row_newbcast:12 row_mask:0xf bank_mask:0xf
  v_and_b32_dpp v39, v49, v7 row_newbcast:12 row_mask:0xf bank_mask:0xf
  s_nop 1
  v_mfma_f32_16x16x32_bf16 v[28:31], v[36:39], v[164:167], v[28:31]
  v_and_b32_dpp v32, v50, v4 row_newbcast:0 row_mask:0xf bank_mask:0xf
  v_and_b32_dpp v33, v50, v5 row_newbcast:0 row_mask:0xf bank_mask:0xf
  v_and_b32_dpp v34, v50, v6 row_newbcast:0 row_mask:0xf bank_mask:0xf
  v_and_b32_dpp v35, v50, v7 row_newbcast:0 row_mask:0xf bank_mask:0xf
  s_nop 1
  v_mfma_f32_16x16x32_bf16 v[28:31], v[32:35], v[168:171], v[28:31]
  s_xor_b32 s60, s97, 0x20400
  s_bitcmp1_b32 s64, 19
  s_waitcnt vmcnt(6)
  s_cbranch_scc1 L_w80
  s_bitcmp0_b32 s65, 19
  s_waitcnt vmcnt(4)
  s_cbranch_scc1 L_w80
  s_waitcnt vmcnt(3)
L_w80:
  buffer_load_dwordx4 v[200:203], v8, s[44:47], s60 offen nt
  v_and_b32_dpp v36, v50, v4 row_newbcast:4 row_mask:0xf bank_mask:0xf
  v_and_b32_dpp v37, v50, v5 row_newbcast:4 row_mask:0xf bank_mask:0xf
  v_and_b32_dpp v38, v50, v6 row_newbcast:4 row_mask:0xf bank_mask:0xf
  v_and_b32_dpp v39, v50, v7 row_newbcast:4 row_mask:0xf bank_mask:0xf
  s_nop 1
  v_mfma_f32_16x16x32_bf16 v[28:31], v[36:39], v[172:175], v[28:31]
  s_xor_b32 s60, s97, 0x22000
  s_bitcmp1_b32 s64, 18
  s_waitcnt vmcnt(6)
  s_cbranch_scc1 L_w81
  s_bitcmp0_b32 s65, 18
  s_waitcnt vmcnt(4)
  s_cbranch_scc1 L_w81
  s_waitcnt vmcnt(3)
L_w81:
  buffer_load_dwordx4 v[204:207], v8, s[44:47], s60 offen nt
  v_and_b32_dpp v32, v50, v4 row_newbcast:8 row_mask:0xf bank_mask:0xf
  v_and_b32_dpp v33, v50, v5 row_newbcast:8 row_mask:0xf bank_mask:0xf
  v_and_b32_dpp v34, v50, v6 row_newbcast:8 row_mask:0xf bank_mask:0xf
  v_and_b32_dpp v35, v50, v7 row_newbcast:8 row_mask:0xf bank_mask:0xf
  s_nop 1
  v_mfma_f32_16x16x32_bf16 v[28:31], v[32:35], v[176:179], v[28:31]
  s_xor_b32 s60, s97, 0x20800
  s_bitcmp1_b32 s64, 17
  s_waitcnt vmcnt(6)
  s_cbranch_scc1 L_w82
  s_bitcmp0_b32 s65, 17
  s_waitcnt vmcnt(4)
  s_cbranch_scc1 L_w82
  s_waitcnt vmcnt(3)
L_w82:
  buffer_load_dwordx4 v[208:211], v8, s[44:47], s60 offen nt
  v_and_b32_dpp v36, v50, v4 row_newbcast:12 row_mask:0xf bank_mask:0xf
  v_and_b32_dpp v37, v50, v5 row_newbcast:12 row_mask:0xf bank_mask:0xf
  v_and_b32_dpp v38, v50, v6 row_newbcast:12 row_mask:0xf bank_mask:0xf
  v_and_b32_dpp v39, v50, v7 row_newbcast:12 row_mask:0xf bank_mask:0xf
  s_nop 1
  v_mfma_f32_16x16x32_bf16 v[28:31], v[36:39], v[180:183], v[28:31]
  s_xor_b32 s60, s97, 0x22c00
  s_bitcmp1_b32 s64, 16
  s_waitcnt vmcnt(6)
  s_cbranch_scc1 L_w83
  s_bitcmp0_b32 s65, 16
  s_waitcnt vmcnt(4)
  s_cbranch_scc1 L_w83
  s_waitcnt vmcnt(3)
L_w83:
  buffer_load_dwordx4 v[212:215], v8, s[44:47], s60 offen nt
  v_and_b32_dpp v32, v51, v4 row_newbcast:0 row_mask:0xf bank_mask:0xf
  v_and_b32_dpp v33, v51, v5 row_newbcast:0 row_mask:0xf bank_mask:0xf
  v_and_b32_dpp v34, v51, v6 row_newbcast:0 row_mask:0xf bank_mask:0xf
  v_and_b32_dpp v35, v51, v7 row_newbcast:0 row_mask:0xf bank_mask:0xf
  s_nop 1
  v_mfma_f32_16x16x32_bf16 v[28:31], v[32:35], v[184:187], v[28:31]
  s_xor_b32 s60, s97, 0x3c000
  s_bitcmp1_b32 s64, 15
  s_waitcnt vmcnt(6)
  s_cbranch_scc1 L_w84
  s_bitcmp0_b32 s65, 15
  s_waitcnt vmcnt(4)
  s_cbranch_scc1 L_w84
  s_waitcnt vmcnt(3)
L_w84:
  buffer_load_dwordx4 v[216:219], v8, s[44:47], s60 offen nt
  v_and_b32_dpp v36, v51, v4 row_newbcast:4 row_mask:0xf bank_mask:0xf
  v_and_b32_dpp v37, v51, v5 row_newbcast:4 row_mask:0xf bank_mask:0xf
  v_and_b32_dpp v38, v51, v6 row_newbcast:4 row_mask:0xf bank_mask:0xf
  v_and_b32_dpp v39, v51, v7 row_newbcast:4 row_mask:0xf bank_mask:0xf
  s_nop 1
  v_mfma_f32_16x16x32_bf16 v[28:31], v[36:39], v[188:191], v[28:31]
  s_xor_b32 s60, s97, 0x3e400
  s_bitcmp1_b32 s64, 14
  s_waitcnt vmcnt(6)
  s_cbranch_scc1 L_w85
  s_bitcmp0_b32 s65, 14
  s_waitcnt vmcnt(4)
  s_cbranch_scc1 L_w85
  s_waitcnt vmcnt(3)
L_w85:
  buffer_load_dwordx4 v[220:223], v8, s[44:47], s60 offen nt
  v_and_b32_dpp v32, v51, v4 row_newbcast:8 row_mask:0xf bank_mask:0xf
  v_and_b32_dpp v33, v51, v5 row_newbcast:8 row_mask:0xf bank_mask:0xf
  v_and_b32_dpp v34, v51, v6 row_newbcast:8 row_mask:0xf bank_mask:0xf
  v_and_b32_dpp v35, v51, v7 row_newbcast:8 row_mask:0xf bank_mask:0xf
  s_nop 1
  v_mfma_f32_16x16x32_bf16 v[28:31], v[32:35], v[192:195], v[28:31]
  s_xor_b32 s60, s97, 0x3cc00
  s_bitcmp1_b32 s64, 13
  s_waitcnt vmcnt(6)
  s_cbranch_scc1 L_w86
  s_bitcmp0_b32 s65, 13
  s_waitcnt vmcnt(4)
  s_cbranch_scc1 L_w86
  s_waitcnt vmcnt(3)
L_w86:
  buffer_load_dwordx4 v[224:227], v8, s[44:47], s60 offen nt
  v_and_b32_dpp v36, v51, v4 row_newbcast:12 row_mask:0xf bank_mask:0xf
  v_and_b32_dpp v37, v51, v5 row_newbcast:12 row_mask:0xf bank_mask:0xf
  v_and_b32_dpp v38, v51, v6 row_newbcast:12 row_mask:0xf bank_mask:0xf
  v_and_b32_dpp v39, v51, v7 row_newbcast:12 row_mask:0xf bank_mask:0xf
  s_nop 1
  v_mfma_f32_16x16x32_bf16 v[28:31], v[36:39], v[196:199], v[28:31]
  s_xor_b32 s60, s97, 0x3e800
  s_bitcmp1_b32 s64, 12
  s_waitcnt vmcnt(6)
  s_cbranch_scc1 L_w87
  s_bitcmp0_b32 s65, 12
  s_waitcnt vmcnt(4)
  s_cbranch_scc1 L_w87
  s_waitcnt vmcnt(3)
L_w87:
  buffer_load_dwordx4 v[228:231], v8, s[44:47], s60 offen nt
  v_and_b32_dpp v32, v52, v4 row_newbcast:0 row_mask:0xf bank_mask:0xf
  v_and_b32_dpp v33, v52, v5 row_newbcast:0 row_mask:0xf bank_mask:0xf
  v_and_b32_dpp v34, v52, v6 row_newbcast:0 row_mask:0xf bank_mask:0xf
  v_and_b32_dpp v35, v52, v7 row_newbcast:0 row_mask:0xf bank_mask:0xf
  s_nop 1
  v_mfma_f32_16x16x32_bf16 v[28:31], v[32:35], v[200:203], v[28:31]
  s_xor_b32 s60, s97, 0x60c00
  s_bitcmp1_b32 s64, 11
  s_waitcnt vmcnt(6)
  s_cbranch_scc1 L_w88
  s_bitcmp0_b32 s65, 11
  s_waitcnt vmcnt(4)
  s_cbranch_scc1 L_w88
  s_waitcnt vmcnt(3)
L_w88:
  buffer_load_dwordx4 v[232:235], v8, s[44:47], s60 offen nt
  v_and_b32_dpp v36, v52, v4 row_newbcast:4 row_mask:0xf bank_mask:0xf
  v_and_b32_dpp v37, v52, v5 row_newbcast:4 row_mask:0xf bank_mask:0xf
  v_and_b32_dpp v38, v52, v6 row_newbcast:4 row_mask:0xf bank_mask:0xf
  v_and_b32_dpp v39, v52, v7 row_newbcast:4 row_mask:0xf bank_mask:0xf
  s_nop 1
  v_mfma_f32_16x16x32_bf16 v[28:31], v[36:39], v[204:207], v[28:31]
  s_xor_b32 s60, s97, 0x62800
  s_bitcmp1_b32 s64, 10
  s_waitcnt vmcnt(6)
  s_cbranch_scc1 L_w89
  s_bitcmp0_b32 s65, 10
  s_waitcnt vmcnt(4)
  s_cbranch_scc1 L_w89
  s_waitcnt vmcnt(3)
L_w89:
  buffer_load_dwordx4 v[236:239], v8, s[44:47], s60 offen nt
  v_and_b32_dpp v32, v52, v4 row_newbcast:8 row_mask:0xf bank_mask:0xf
  v_and_b32_dpp v33, v52, v5 row_newbcast:8 row_mask:0xf bank_mask:0xf
  v_and_b32_dpp v34, v52, v6 row_newbcast:8 row_mask:0xf bank_mask:0xf
  v_and_b32_dpp v35, v52, v7 row_newbcast:8 row_mask:0xf bank_mask:0xf
  s_nop 1
  v_mfma_f32_16x16x32_bf16 v[28:31], v[32:35], v[208:211], v[28:31]
  s_xor_b32 s60, s97, 0x60000
  s_bitcmp1_b32 s64, 9
  s_waitcnt vmcnt(6)
  s_cbranch_scc1 L_w90
  s_bitcmp0_b32 s65, 9
  s_waitcnt vmcnt(4)
  s_cbranch_scc1 L_w90
  s_waitcnt vmcnt(3)
L_w90:
  buffer_load_dwordx4 v[240:243], v8, s[44:47], s60 offen nt
  s_mov_b64 exec, 1
  ds_add_u32 v26, v27 offset:160
  s_mov_b64 exec, -1
  v_and_b32_dpp v36, v52, v4 row_newbcast:12 row_mask:0xf bank_mask:0xf
  v_and_b32_dpp v37, v52, v5 row_newbcast:12 row_mask:0xf bank_mask:0xf
  v_and_b32_dpp v38, v52, v6 row_newbcast:12 row_mask:0xf bank_mask:0xf
  v_and_b32_dpp v39, v52, v7 row_newbcast:12 row_mask:0xf bank_mask:0xf
  s_nop 1
  v_mfma_f32_16x16x32_bf16 v[28:31], v[36:39], v[212:215], v[28:31]
  s_xor_b32 s60, s97, 0x62400
  s_bitcmp1_b32 s64, 8
  s_waitcnt vmcnt(6)
  s_cbranch_scc1 L_w91
  s_bitcmp0_b32 s65, 8
  s_waitcnt vmcnt(4)
  s_cbranch_scc1 L_w91
  s_waitcnt vmcnt(3)
L_w91:
  buffer_load_dwordx4 v[244:247], v8, s[44:47], s60 offen nt
  v_and_b32_dpp v32, v53, v4 row_newbcast:0 row_mask:0xf bank_mask:0xf
  v_and_b32_dpp v33, v53, v5 row_newbcast:0 row_mask:0xf bank_mask:0xf
  v_and_b32_dpp v34, v53, v6 row_newbcast:0 row_mask:0xf bank_mask:0xf
  v_and_b32_dpp v35, v53, v7 row_newbcast:0 row_mask:0xf bank_mask:0xf
  s_nop 1
  v_mfma_f32_16x16x32_bf16 v[28:31], v[32:35], v[216:219], v[28:31]
  s_xor_b32 s60, s97, 0x7c800
  s_bitcmp1_b32 s64, 7
  s_waitcnt vmcnt(6)
  s_cbranch_scc1 L_w92
  s_bitcmp0_b32 s65, 7
  s_waitcnt vmcnt(4)
  s_cbranch_scc1 L_w92
  s_waitcnt vmcnt(3)
L_w92:
  buffer_load_dwordx4 v[64:67], v8, s[44:47], s60 offen nt
  v_and_b32_dpp v36, v53, v4 row_newbcast:4 row_mask:0xf bank_mask:0xf
  v_and_b32_dpp v37, v53, v5 row_newbcast:4 row_mask:0xf bank_mask:0xf
  v_and_b32_dpp v38, v53, v6 row_newbcast:4 row_mask:0xf bank_mask:0xf
  v_and_b32_dpp v39, v53, v7 row_newbcast:4 row_mask:0xf bank_mask:0xf
  s_nop 1
  v_mfma_f32_16x16x32_bf16 v[28:31], v[36:39], v[220:223], v[28:31]
  s_xor_b32 s60, s97, 0x7ec00
  s_bitcmp1_b32 s64, 6
  s_waitcnt vmcnt(6)
  s_cbranch_scc1 L_w93
  s_bitcmp0_b32 s65, 6
  s_waitcnt vmcnt(4)
  s_cbranch_scc1 L_w93
  s_waitcnt vmcnt(3)
L_w93:
  buffer_load_dwordx4 v[68:71], v8, s[44:47], s60 offen nt
  v_and_b32_dpp v32, v53, v4 row_newbcast:8 row_mask:0xf bank_mask:0xf
  v_and_b32_dpp v33, v53, v5 row_newbcast:8 row_mask:0xf bank_mask:0xf
  v_and_b32_dpp v34, v53, v6 row_newbcast:8 row_mask:0xf bank_mask:0xf
  v_and_b32_dpp v35, v53, v7 row_newbcast:8 row_mask:0xf bank_mask:0xf
  s_nop 1
  v_mfma_f32_16x16x32_bf16 v[28:31], v[32:35], v[224:227], v[28:31]
  s_xor_b32 s60, s97, 0x7c400
  s_bitcmp1_b32 s64, 5
  s_waitcnt vmcnt(6)
  s_cbranch_scc1 L_w94
  s_bitcmp0_b32 s65, 5
  s_waitcnt vmcnt(4)
  s_cbranch_scc1 L_w94
  s_waitcnt vmcnt(3)
L_w94:
  buffer_load_dwordx4 v[72:75], v8, s[44:47], s60 offen nt
  v_and_b32_dpp v36, v53, v4 row_newbcast:12 row_mask:0xf bank_mask:0xf
  v_and_b32_dpp v37, v53, v5 row_newbcast:12 row_mask:0xf bank_mask:0xf
  v_and_b32_dpp v38, v53, v6 row_newbcast:12 row_mask:0xf bank_mask:0xf
  v_and_b32_dpp v39, v53, v7 row_newbcast:12 row_mask:0xf bank_mask:0xf
  s_nop 1
  v_mfma_f32_16x16x32_bf16 v[28:31], v[36:39], v[228:231], v[28:31]
  s_xor_b32 s60, s97, 0x7e000
  s_bitcmp1_b32 s64, 4
  s_waitcnt vmcnt(6)
  s_cbranch_scc1 L_w95
  s_bitcmp0_b32 s65, 4
  s_waitcnt vmcnt(4)
  s_cbranch_scc1 L_w95
  s_waitcnt vmcnt(3)
L_w95:
  buffer_load_dwordx4 v[76:79], v8, s[44:47], s60 offen nt
  v_and_b32_dpp v32, v54, v4 row_newbcast:0 row_mask:0xf bank_mask:0xf
  v_and_b32_dpp v33, v54, v5 row_newbcast:0 row_mask:0xf bank_mask:0xf
  v_and_b32_dpp v34, v54, v6 row_newbcast:0 row_mask:0xf bank_mask:0xf
  v_and_b32_dpp v35, v54, v7 row_newbcast:0 row_mask:0xf bank_mask:0xf
  s_nop 1
  v_mfma_f32_16x16x32_bf16 v[28:31], v[32:35], v[232:235], v[28:31]
  s_xor_b32 s60, s97, 0x80000
  s_bitcmp1_b32 s64, 3
  s_waitcnt vmcnt(6)
  s_cbranch_scc1 L_w96
  s_bitcmp0_b32 s65, 3
  s_waitcnt vmcnt(4)
  s_cbranch_scc1 L_w96
  s_waitcnt vmcnt(3)
L_w96:
  buffer_load_dwordx4 v[80:83], v8, s[44:47], s60 offen nt
  v_and_b32_dpp v36, v54, v4 row_newbcast:4 row_mask:0xf bank_mask:0xf
  v_and_b32_dpp v37, v54, v5 row_newbcast:4 row_mask:0xf bank_mask:0xf
  v_and_b32_dpp v38, v54, v6 row_newbcast:4 row_mask:0xf bank_mask:0xf
  v_and_b32_dpp v39, v54, v7 row_newbcast:4 row_mask:0xf bank_mask:0xf
  s_nop 1
  v_mfma_f32_16x16x32_bf16 v[28:31], v[36:39], v[236:239], v[28:31]
  s_xor_b32 s60, s97, 0x82400
  s_bitcmp1_b32 s64, 2
  s_waitcnt vmcnt(6)
  s_cbranch_scc1 L_w97
  s_bitcmp0_b32 s65, 2
  s_waitcnt vmcnt(4)
  s_cbranch_scc1 L_w97
  s_waitcnt vmcnt(3)
L_w97:
  buffer_load_dwordx4 v[84:87], v8, s[44:47], s60 offen nt
  v_and_b32_dpp v32, v54, v4 row_newbcast:8 row_mask:0xf bank_mask:0xf
  v_and_b32_dpp v33, v54, v5 row_newbcast:8 row_mask:0xf bank_mask:0xf
  v_and_b32_dpp v34, v54, v6 row_newbcast:8 row_mask:0xf bank_mask:0xf
  v_and_b32_dpp v35, v54, v7 row_newbcast:8 row_mask:0xf bank_mask:0xf
  s_nop 1
  v_mfma_f32_16x16x32_bf16 v[28:31], v[32:35], v[240:243], v[28:31]
  s_xor_b32 s60, s97, 0x80c00
  s_bitcmp1_b32 s64, 1
  s_waitcnt vmcnt(6)
  s_cbranch_scc1 L_w98
  s_bitcmp0_b32 s65, 1
  s_waitcnt vmcnt(4)
  s_cbranch_scc1 L_w98
  s_waitcnt vmcnt(3)
L_w98:
  buffer_load_dwordx4 v[88:91], v8, s[44:47], s60 offen nt
  v_and_b32_dpp v36, v54, v4 row_newbcast:12 row_mask:0xf bank_mask:0xf
  v_and_b32_dpp v37, v54, v5 row_newbcast:12 row_mask:0xf bank_mask:0xf
  v_and_b32_dpp v38, v54, v6 row_newbcast:12 row_mask:0xf bank_mask:0xf
  v_and_b32_dpp v39, v54, v7 row_newbcast:12 row_mask:0xf bank_mask:0xf
  s_nop 1
  v_mfma_f32_16x16x32_bf16 v[28:31], v[36:39], v[244:247], v[28:31]
  ds_read2_b32 v[44:45], v26 offset0:44 offset1:52
  s_xor_b32 s60, s97, 0x82800
  s_bitcmp1_b32 s64, 0
  s_waitcnt vmcnt(6)
  s_cbranch_scc1 L_w99
  s_bitcmp0_b32 s65, 0
  s_waitcnt vmcnt(4)
  s_cbranch_scc1 L_w99
  s_waitcnt vmcnt(3)
L_w99:
  buffer_load_dwordx4 v[92:95], v8, s[44:47], s60 offen nt
  s_waitcnt lgkmcnt(0)
  v_readfirstlane_b32 s64, v44
  v_readfirstlane_b32 s65, v45
  v_and_b32_dpp v32, v55, v4 row_newbcast:0 row_mask:0xf bank_mask:0xf
  v_and_b32_dpp v33, v55, v5 row_newbcast:0 row_mask:0xf bank_mask:0xf
  v_and_b32_dpp v34, v55, v6 row_newbcast:0 row_mask:0xf bank_mask:0xf
  v_and_b32_dpp v35, v55, v7 row_newbcast:0 row_mask:0xf bank_mask:0xf
  s_nop 1
  v_mfma_f32_16x16x32_bf16 v[28:31], v[32:35], v[64:67], v[28:31]
  s_xor_b32 s60, s97, 0x9c400
  s_bitcmp1_b32 s64, 17
  s_waitcnt vmcnt(6)
  s_cbranch_scc1 L_w100
  s_bitcmp0_b32 s65, 17
  s_waitcnt vmcnt(4)
  s_cbranch_scc1 L_w100
  s_waitcnt vmcnt(3)
L_w100:
  buffer_load_dwordx4 v[96:99], v8, s[44:47], s60 offen nt
  v_and_b32_dpp v36, v55, v4 row_newbcast:4 row_mask:0xf bank_mask:0xf
  v_and_b32_dpp v37, v55, v5 row_newbcast:4 row_mask:0xf bank_mask:0xf
  v_and_b32_dpp v38, v55, v6 row_newbcast:4 row_mask:0xf bank_mask:0xf
  v_and_b32_dpp v39, v55, v7 row_newbcast:4 row_mask:0xf bank_mask:0xf
  s_nop 1
  v_mfma_f32_16x16x32_bf16 v[28:31], v[36:39], v[68:71], v[28:31]
  s_xor_b32 s60, s97, 0x9e000
  s_bitcmp1_b32 s64, 16
  s_waitcnt vmcnt(6)
  s_cbranch_scc1 L_w101
  s_bitcmp0_b32 s65, 16
  s_waitcnt vmcnt(4)
  s_cbranch_scc1 L_w101
  s_waitcnt vmcnt(3)
L_w101:
  buffer_load_dwordx4 v[100:103], v8, s[44:47], s60 offen nt
  v_and_b32_dpp v32, v55, v4 row_newbcast:8 row_mask:0xf bank_mask:0xf
  v_and_b32_dpp v33, v55, v5 row_newbcast:8 row_mask:0xf bank_mask:0xf
  v_and_b32_dpp v34, v55, v6 row_newbcast:8 row_mask:0xf bank_mask:0xf
  v_and_b32_dpp v35, v55, v7 row_newbcast:8 row_mask:0xf bank_mask:0xf
  s_nop 1
  v_mfma_f32_16x16x32_bf16 v[28:31], v[32:35], v[72:75], v[28:31]
  s_xor_b32 s60, s97, 0x9c800
  s_bitcmp1_b32 s64, 15
  s_waitcnt vmcnt(6)
  s_cbranch_scc1 L_w102
  s_bitcmp0_b32 s65, 15
  s_waitcnt vmcnt(4)
  s_cbranch_scc1 L_w102
  s_waitcnt vmcnt(3)
L_w102:
  buffer_load_dwordx4 v[104:107], v8, s[44:47], s60 offen nt
  v_and_b32_dpp v36, v55, v4 row_newbcast:12 row_mask:0xf bank_mask:0xf
  v_and_b32_dpp v37, v55, v5 row_newbcast:12 row_mask:0xf bank_mask:0xf
  v_and_b32_dpp v38, v55, v6 row_newbcast:12 row_mask:0xf bank_mask:0xf
  v_and_b32_dpp v39, v55, v7 row_newbcast:12 row_mask:0xf bank_mask:0xf
  s_nop 1
  v_mfma_f32_16x16x32_bf16 v[28:31], v[36:39], v[76:79], v[28:31]
  ds_read2_b32 v[44:45], v26 offset0:44 offset1:52
  s_xor_b32 s60, s97, 0x9ec00
  s_bitcmp1_b32 s64, 14
  s_waitcnt vmcnt(6)
  s_cbranch_scc1 L_w103
  s_bitcmp0_b32 s65, 14
  s_waitcnt vmcnt(4)
  s_cbranch_scc1 L_w103
  s_waitcnt vmcnt(3)
L_w103:
  buffer_load_dwordx4 v[108:111], v8, s[44:47], s60 offen nt
  s_waitcnt lgkmcnt(0)
  v_readfirstlane_b32 s64, v44
  v_readfirstlane_b32 s65, v45
  v_and_b32_dpp v32, v56, v4 row_newbcast:0 row_mask:0xf bank_mask:0xf
  v_and_b32_dpp v33, v56, v5 row_newbcast:0 row_mask:0xf bank_mask:0xf
  v_and_b32_dpp v34, v56, v6 row_newbcast:0 row_mask:0xf bank_mask:0xf
  v_and_b32_dpp v35, v56, v7 row_newbcast:0 row_mask:0xf bank_mask:0xf
  s_nop 1
  v_mfma_f32_16x16x32_bf16 v[28:31], v[32:35], v[80:83], v[28:31]
  s_xor_b32 s60, s97, 0xc0800
  s_bitcmp1_b32 s64, 13
  s_waitcnt vmcnt(6)
  s_cbranch_scc1 L_w104
  s_bitcmp0_b32 s65, 13
  s_waitcnt vmcnt(4)
  s_cbranch_scc1 L_w104
  s_waitcnt vmcnt(3)
L_w104:
  buffer_load_dwordx4 v[112:115], v8, s[44:47], s60 offen nt
  v_and_b32_dpp v36, v56, v4 row_newbcast:4 row_mask:0xf bank_mask:0xf
  v_and_b32_dpp v37, v56, v5 row_newbcast:4 row_mask:0xf bank_mask:0xf
  v_and_b32_dpp v38, v56, v6 row_newbcast:4 row_mask:0xf bank_mask:0xf
  v_and_b32_dpp v39, v56, v7 row_newbcast:4 row_mask:0xf bank_mask:0xf
  s_nop 1
  v_mfma_f32_16x16x32_bf16 v[28:31], v[36:39], v[84:87], v[28:31]
  s_xor_b32 s60, s97, 0xc2c00
  s_bitcmp1_b32 s64, 12
  s_waitcnt vmcnt(6)
  s_cbranch_scc1 L_w105
  s_bitcmp0_b32 s65, 12
  s_waitcnt vmcnt(4)
  s_cbranch_scc1 L_w105
  s_waitcnt vmcnt(3)
L_w105:
  buffer_load_dwordx4 v[116:119], v8, s[44:47], s60 offen nt
  v_and_b32_dpp v32, v56, v4 row_newbcast:8 row_mask:0xf bank_mask:0xf
  v_and_b32_dpp v33, v56, v5 row_newbcast:8 row_mask:0xf bank_mask:0xf
  v_and_b32_dpp v34, v56, v6 row_newbcast:8 row_mask:0xf bank_mask:0xf
  v_and_b32_dpp v35, v56, v7 row_newbcast:8 row_mask:0xf bank_mask:0xf
  s_nop 1
  v_mfma_f32_16x16x32_bf16 v[28:31], v[32:35], v[88:91], v[28:31]
  s_xor_b32 s60, s97, 0xc0400
  s_bitcmp1_b32 s64, 11
  s_waitcnt vmcnt(6)
  s_cbranch_scc1 L_w106
  s_bitcmp0_b32 s65, 11
  s_waitcnt vmcnt(4)
  s_cbranch_scc1 L_w106
  s_waitcnt vmcnt(3)
L_w106:
  buffer_load_dwordx4 v[120:123], v8, s[44:47], s60 offen nt
  v_and_b32_dpp v36, v56, v4 row_newbcast:12 row_mask:0xf bank_mask:0xf
  v_and_b32_dpp v37, v56, v5 row_newbcast:12 row_mask:0xf bank_mask:0xf
  v_and_b32_dpp v38, v56, v6 row_newbcast:12 row_mask:0xf bank_mask:0xf
  v_and_b32_dpp v39, v56, v7 row_newbcast:12 row_mask:0xf bank_mask:0xf
  s_nop 1
  v_mfma_f32_16x16x32_bf16 v[28:31], v[36:39], v[92:95], v[28:31]
  s_xor_b32 s60, s97, 0xc2000
  s_bitcmp1_b32 s64, 10
  s_waitcnt vmcnt(6)
  s_cbranch_scc1 L_w107
  s_bitcmp0_b32 s65, 10
  s_waitcnt vmcnt(4)
  s_cbranch_scc1 L_w107
  s_waitcnt vmcnt(3)
L_w107:
  buffer_load_dwordx4 v[124:127], v8, s[44:47], s60 offen nt
  v_and_b32_dpp v32, v57, v4 row_newbcast:0 row_mask:0xf bank_mask:0xf
  v_and_b32_dpp v33, v57, v5 row_newbcast:0 row_mask:0xf bank_mask:0xf
  v_and_b32_dpp v34, v57, v6 row_newbcast:0 row_mask:0xf bank_mask:0xf
  v_and_b32_dpp v35, v57, v7 row_newbcast:0 row_mask:0xf bank_mask:0xf
  s_nop 1
  v_mfma_f32_16x16x32_bf16 v[28:31], v[32:35], v[96:99], v[28:31]
  s_xor_b32 s60, s97, 0xdcc00
  s_bitcmp1_b32 s64, 9
  s_waitcnt vmcnt(6)
  s_cbranch_scc1 L_w108
  s_bitcmp0_b32 s65, 9
  s_waitcnt vmcnt(4)
  s_cbranch_scc1 L_w108
  s_waitcnt vmcnt(3)
L_w108:
  buffer_load_dwordx4 v[128:131], v8, s[44:47], s60 offen nt
  v_and_b32_dpp v36, v57, v4 row_newbcast:4 row_mask:0xf bank_mask:0xf
  v_and_b32_dpp v37, v57, v5 row_newbcast:4 row_mask:0xf bank_mask:0xf
  v_and_b32_dpp v38, v57, v6 row_newbcast:4 row_mask:0xf bank_mask:0xf
  v_and_b32_dpp v39, v57, v7 row_newbcast:4 row_mask:0xf bank_mask:0xf
  s_nop 1
  v_mfma_f32_16x16x32_bf16 v[28:31], v[36:39], v[100:103], v[28:31]
  s_xor_b32 s60, s97, 0xde800
  s_bitcmp1_b32 s64, 8
  s_waitcnt vmcnt(6)
  s_cbranch_scc1 L_w109
  s_bitcmp0_b32 s65, 8
  s_waitcnt vmcnt(4)
  s_cbranch_scc1 L_w109
  s_waitcnt vmcnt(3)
L_w109:
  buffer_load_dwordx4 v[132:135], v8, s[44:47], s60 offen nt
  v_and_b32_dpp v32, v57, v4 row_newbcast:8 row_mask:0xf bank_mask:0xf
  v_and_b32_dpp v33, v57, v5 row_newbcast:8 row_mask:0xf bank_mask:0xf
  v_and_b32_dpp v34, v57, v6 row_newbcast:8 row_mask:0xf bank_mask:0xf
  v_and_b32_dpp v35, v57, v7 row_newbcast:8 row_mask:0xf bank_mask:0xf
  s_nop 1
  v_mfma_f32_16x16x32_bf16 v[28:31], v[32:35], v[104:107], v[28:31]
  s_xor_b32 s60, s97, 0xdc000
  s_bitcmp1_b32 s64, 7
  s_waitcnt vmcnt(6)
  s_cbranch_scc1 L_w110
  s_bitcmp0_b32 s65, 7
  s_waitcnt vmcnt(4)
  s_cbranch_scc1 L_w110
  s_waitcnt vmcnt(3)
L_w110:
  buffer_load_dwordx4 v[136:139], v8, s[44:47], s60 offen nt
  v_and_b32_dpp v36, v57, v4 row_newbcast:12 row_mask:0xf bank_mask:0xf
  v_and_b32_dpp v37, v57, v5 row_newbcast:12 row_mask:0xf bank_mask:0xf
  v_and_b32_dpp v38, v57, v6 row_newbcast:12 row_mask:0xf bank_mask:0xf
  v_and_b32_dpp v39, v57, v7 row_newbcast:12 row_mask:0xf bank_mask:0xf
  s_nop 1
  v_mfma_f32_16x16x32_bf16 v[28:31], v[36:39], v[108:111], v[28:31]
  s_xor_b32 s60, s97, 0xde400
  s_bitcmp1_b32 s64, 6
  s_waitcnt vmcnt(6)
  s_cbranch_scc1 L_w111
  s_bitcmp0_b32 s65, 6
  s_waitcnt vmcnt(4)
  s_cbranch_scc1 L_w111
  s_waitcnt vmcnt(3)
L_w111:
  buffer_load_dwordx4 v[140:143], v8, s[44:47], s60 offen nt
  v_and_b32_dpp v32, v58, v4 row_newbcast:0 row_mask:0xf bank_mask:0xf
  v_and_b32_dpp v33, v58, v5 row_newbcast:0 row_mask:0xf bank_mask:0xf
  v_and_b32_dpp v34, v58, v6 row_newbcast:0 row_mask:0xf bank_mask:0xf
  v_and_b32_dpp v35, v58, v7 row_newbcast:0 row_mask:0xf bank_mask:0xf
  s_nop 1
  v_mfma_f32_16x16x32_bf16 v[28:31], v[32:35], v[112:115], v[28:31]
  s_xor_b32 s60, s97, 0xa0400
  s_bitcmp1_b32 s64, 5
  s_waitcnt vmcnt(6)
  s_cbranch_scc1 L_w112
  s_bitcmp0_b32 s65, 5
  s_waitcnt vmcnt(4)
  s_cbranch_scc1 L_w112
  s_waitcnt vmcnt(3)
L_w112:
  buffer_load_dwordx4 v[144:147], v8, s[44:47], s60 offen nt
L_fw:
  ds_read_b32 v20, v26 offset:128
  ds_read_b128 v[40:43], v26 offset:144
  s_waitcnt lgkmcnt(0)
  v_readfirstlane_b32 s70, v20
  s_cmp_eq_u32 s70, 0
  s_cbranch_scc1 L_fw
  v_and_b32_dpp v36, v58, v4 row_newbcast:4 row_mask:0xf bank_mask:0xf
  v_and_b32_dpp v37, v58, v5 row_newbcast:4 row_mask:0xf bank_mask:0xf
  v_and_b32_dpp v38, v58, v6 row_newbcast:4 row_mask:0xf bank_mask:0xf
  v_and_b32_dpp v39, v58, v7 row_newbcast:4 row_mask:0xf bank_mask:0xf
  s_nop 1
  v_mfma_f32_16x16x32_bf16 v[28:31], v[36:39], v[116:119], v[28:31]
  s_xor_b32 s60, s97, 0xa2000
  s_bitcmp1_b32 s64, 4
  s_waitcnt vmcnt(6)
  s_cbranch_scc1 L_w113
  s_bitcmp0_b32 s65, 4
  s_waitcnt vmcnt(4)
  s_cbranch_scc1 L_w113
  s_waitcnt vmcnt(3)
L_w113:
  buffer_load_dwordx4 v[148:151], v8, s[44:47], s60 offen nt
  v_and_b32_dpp v32, v58, v4 row_newbcast:8 row_mask:0xf bank_mask:0xf
  v_and_b32_dpp v33, v58, v5 row_newbcast:8 row_mask:0xf bank_mask:0xf
  v_and_b32_dpp v34, v58, v6 row_newbcast:8 row_mask:0xf bank_mask:0xf
  v_and_b32_dpp v35, v58, v7 row_newbcast:8 row_mask:0xf bank_mask:0xf
  s_nop 1
  v_mfma_f32_16x16x32_bf16 v[28:31], v[32:35], v[120:123], v[28:31]
  s_xor_b32 s60, s97, 0xa0800
  s_bitcmp1_b32 s64, 3
  s_waitcnt vmcnt(6)
  s_cbranch_scc1 L_w114
  s_bitcmp0_b32 s65, 3
  s_waitcnt vmcnt(4)
  s_cbranch_scc1 L_w114
  s_waitcnt vmcnt(3)
L_w114:
  buffer_load_dwordx4 v[152:155], v8, s[44:47], s60 offen nt
  v_and_b32_dpp v36, v58, v4 row_newbcast:12 row_mask:0xf bank_mask:0xf
  v_and_b32_dpp v37, v58, v5 row_newbcast:12 row_mask:0xf bank_mask:0xf
  v_and_b32_dpp v38, v58, v6 row_newbcast:12 row_mask:0xf bank_mask:0xf
  v_and_b32_dpp v39, v58, v7 row_newbcast:12 row_mask:0xf bank_mask:0xf
  s_nop 1
  v_mfma_f32_16x16x32_bf16 v[28:31], v[36:39], v[124:127], v[28:31]
  s_xor_b32 s60, s97, 0xa2c00
  s_bitcmp1_b32 s64, 2
  s_waitcnt vmcnt(6)
  s_cbranch_scc1 L_w115
  s_bitcmp0_b32 s65, 2
  s_waitcnt vmcnt(4)
  s_cbranch_scc1 L_w115
  s_waitcnt vmcnt(3)
L_w115:
  buffer_load_dwordx4 v[156:159], v8, s[44:47], s60 offen nt
  v_and_b32_dpp v32, v59, v4 row_newbcast:0 row_mask:0xf bank_mask:0xf
  v_and_b32_dpp v33, v59, v5 row_newbcast:0 row_mask:0xf bank_mask:0xf
  v_and_b32_dpp v34, v59, v6 row_newbcast:0 row_mask:0xf bank_mask:0xf
  v_and_b32_dpp v35, v59, v7 row_newbcast:0 row_mask:0xf bank_mask:0xf
  s_nop 1
  v_mfma_f32_16x16x32_bf16 v[28:31], v[32:35], v[128:131], v[28:31]
  s_xor_b32 s60, s97, 0xbc000
  s_bitcmp1_b32 s64, 1
  s_waitcnt vmcnt(6)
  s_cbranch_scc1 L_w116
  s_bitcmp0_b32 s65, 1
  s_waitcnt vmcnt(4)
  s_cbranch_scc1 L_w116
  s_waitcnt vmcnt(3)
L_w116:
  buffer_load_dwordx4 v[160:163], v8, s[44:47], s60 offen nt
  v_and_b32_dpp v36, v59, v4 row_newbcast:4 row_mask:0xf bank_mask:0xf
  v_and_b32_dpp v37, v59, v5 row_newbcast:4 row_mask:0xf bank_mask:0xf
  v_and_b32_dpp v38, v59, v6 row_newbcast:4 row_mask:0xf bank_mask:0xf
  v_and_b32_dpp v39, v59, v7 row_newbcast:4 row_mask:0xf bank_mask:0xf
  s_nop 1
  v_mfma_f32_16x16x32_bf16 v[28:31], v[36:39], v[132:135], v[28:31]
  s_xor_b32 s60, s97, 0xbe400
  s_bitcmp1_b32 s64, 0
  s_waitcnt vmcnt(6)
  s_cbranch_scc1 L_w117
  s_bitcmp0_b32 s65, 0
  s_waitcnt vmcnt(4)
  s_cbranch_scc1 L_w117
  s_waitcnt vmcnt(3)
L_w117:
  buffer_load_dwordx4 v[164:167], v8, s[44:47], s60 offen nt
  v_and_b32_dpp v32, v59, v4 row_newbcast:8 row_mask:0xf bank_mask:0xf
  v_and_b32_dpp v33, v59, v5 row_newbcast:8 row_mask:0xf bank_mask:0xf
  v_and_b32_dpp v34, v59, v6 row_newbcast:8 row_mask:0xf bank_mask:0xf
  v_and_b32_dpp v35, v59, v7 row_newbcast:8 row_mask:0xf bank_mask:0xf
  s_nop 1
  v_mfma_f32_16x16x32_bf16 v[28:31], v[32:35], v[136:139], v[28:31]
  s_xor_b32 s60, s97, 0xbcc00
  s_waitcnt vmcnt(7)
  buffer_load_dwordx4 v[168:171], v8, s[44:47], s60 offen nt
  s_xor_b32 s60, s97, 0xbe800
  s_waitcnt vmcnt(7)
  buffer_load_dwordx4 v[172:175], v8, s[44:47], s60 offen nt
  v_and_b32_dpp v36, v59, v4 row_newbcast:12 row_mask:0xf bank_mask:0xf
  v_and_b32_dpp v37, v59, v5 row_newbcast:12 row_mask:0xf bank_mask:0xf
  v_and_b32_dpp v38, v59, v6 row_newbcast:12 row_mask:0xf bank_mask:0xf
  v_and_b32_dpp v39, v59, v7 row_newbcast:12 row_mask:0xf bank_mask:0xf
  s_nop 1
  v_mfma_f32_16x16x32_bf16 v[28:31], v[36:39], v[140:143], v[28:31]
  s_xor_b32 s60, s97, 0xe0c00
  s_waitcnt vmcnt(7)
  buffer_load_dwordx4 v[176:179], v8, s[44:47], s60 offen nt
  v_and_b32_dpp v32, v60, v4 row_newbcast:0 row_mask:0xf bank_mask:0xf
  v_and_b32_dpp v33, v60, v5 row_newbcast:0 row_mask:0xf bank_mask:0xf
  v_and_b32_dpp v34, v60, v6 row_newbcast:0 row_mask:0xf bank_mask:0xf
  v_and_b32_dpp v35, v60, v7 row_newbcast:0 row_mask:0xf bank_mask:0xf
  s_nop 1
  v_mfma_f32_16x16x32_bf16 v[28:31], v[32:35], v[144:147], v[28:31]
  s_xor_b32 s60, s97, 0xe2800
  s_waitcnt vmcnt(7)
  buffer_load_dwordx4 v[180:183], v8, s[44:47], s60 offen nt
  v_and_b32_dpp v36, v60, v4 row_newbcast:4 row_mask:0xf bank_mask:0xf
  v_and_b32_dpp v37, v60, v5 row_newbcast:4 row_mask:0xf bank_mask:0xf
  v_and_b32_dpp v38, v60, v6 row_newbcast:4 row_mask:0xf bank_mask:0xf
  v_and_b32_dpp v39, v60, v7 row_newbcast:4 row_mask:0xf bank_mask:0xf
  s_nop 1
  v_mfma_f32_16x16x32_bf16 v[28:31], v[36:39], v[148:151], v[28:31]
  s_xor_b32 s60, s97, 0xe0000
  s_waitcnt vmcnt(7)
  buffer_load_dwordx4 v[184:187], v8, s[44:47], s60 offen nt
  v_and_b32_dpp v32, v60, v4 row_newbcast:8 row_mask:0xf bank_mask:0xf
  v_and_b32_dpp v33, v60, v5 row_newbcast:8 row_mask:0xf bank_mask:0xf
  v_and_b32_dpp v34, v60, v6 row_newbcast:8 row_mask:0xf bank_mask:0xf
  v_and_b32_dpp v35, v60, v7 row_newbcast:8 row_mask:0xf bank_mask:0xf
  s_nop 1
  v_mfma_f32_16x16x32_bf16 v[28:31], v[32:35], v[152:155], v[28:31]
  s_xor_b32 s60, s97, 0xe2400
  s_waitcnt vmcnt(7)
  buffer_load_dwordx4 v[188:191], v8, s[44:47], s60 offen nt
  v_and_b32_dpp v36, v60, v4 row_newbcast:12 row_mask:0xf bank_mask:0xf
  v_and_b32_dpp v37, v60, v5 row_newbcast:12 row_mask:0xf bank_mask:0xf
  v_and_b32_dpp v38, v60, v6 row_newbcast:12 row_mask:0xf bank_mask:0xf
  v_and_b32_dpp v39, v60, v7 row_newbcast:12 row_mask:0xf bank_mask:0xf
  s_nop 1
  v_mfma_f32_16x16x32_bf16 v[28:31], v[36:39], v[156:159], v[28:31]
  s_xor_b32 s60, s97, 0xfc800
  s_waitcnt vmcnt(7)
  buffer_load_dwordx4 v[192:195], v8, s[44:47], s60 offen nt
  v_and_b32_dpp v32, v61, v4 row_newbcast:0 row_mask:0xf bank_mask:0xf
  v_and_b32_dpp v33, v61, v5 row_newbcast:0 row_mask:0xf bank_mask:0xf
  v_and_b32_dpp v34, v61, v6 row_newbcast:0 row_mask:0xf bank_mask:0xf
  v_and_b32_dpp v35, v61, v7 row_newbcast:0 row_mask:0xf bank_mask:0xf
  s_nop 1
  v_mfma_f32_16x16x32_bf16 v[28:31], v[32:35], v[160:163], v[28:31]
  s_xor_b32 s60, s97, 0xfec00
  s_waitcnt vmcnt(7)
  buffer_load_dwordx4 v[196:199], v8, s[44:47], s60 offen nt
  v_and_b32_dpp v36, v61, v4 row_newbcast:4 row_mask:0xf bank_mask:0xf
  v_and_b32_dpp v37, v61, v5 row_newbcast:4 row_mask:0xf bank_mask:0xf
  v_and_b32_dpp v38, v61, v6 row_newbcast:4 row_mask:0xf bank_mask:0xf
  v_and_b32_dpp v39, v61, v7 row_newbcast:4 row_mask:0xf bank_mask:0xf
  s_nop 1
  v_mfma_f32_16x16x32_bf16 v[28:31], v[36:39], v[164:167], v[28:31]
  s_xor_b32 s60, s97, 0xfc400
  s_waitcnt vmcnt(7)
  buffer_load_dwordx4 v[200:203], v8, s[44:47], s60 offen nt
  ds_write_b32 v26, v27 offset:96
  v_and_b32_dpp v32, v61, v4 row_newbcast:8 row_mask:0xf bank_mask:0xf
  v_and_b32_dpp v33, v61, v5 row_newbcast:8 row_mask:0xf bank_mask:0xf
  v_and_b32_dpp v34, v61, v6 row_newbcast:8 row_mask:0xf bank_mask:0xf
  v_and_b32_dpp v35, v61, v7 row_newbcast:8 row_mask:0xf bank_mask:0xf
  s_nop 1
  v_mfma_f32_16x16x32_bf16 v[28:31], v[32:35], v[168:171], v[28:31]
  s_xor_b32 s60, s97, 0xfe000
  s_waitcnt vmcnt(7)
  buffer_load_dwordx4 v[204:207], v8, s[44:47], s60 offen nt
  s_mov_b64 exec, 1
  ds_add_u32 v26, v27 offset:112
  s_mov_b64 exec, -1
  v_and_b32_dpp v36, v61, v4 row_newbcast:12 row_mask:0xf bank_mask:0xf
  v_and_b32_dpp v37, v61, v5 row_newbcast:12 row_mask:0xf bank_mask:0xf
  v_and_b32_dpp v38, v61, v6 row_newbcast:12 row_mask:0xf bank_mask:0xf
  v_and_b32_dpp v39, v61, v7 row_newbcast:12 row_mask:0xf bank_mask:0xf
  s_nop 1
  v_mfma_f32_16x16x32_bf16 v[28:31], v[36:39], v[172:175], v[28:31]
  v_and_b32_dpp v32, v62, v4 row_newbcast:0 row_mask:0xf bank_mask:0xf
  v_and_b32_dpp v33, v62, v5 row_newbcast:0 row_mask:0xf bank_mask:0xf
  v_and_b32_dpp v34, v62, v6 row_newbcast:0 row_mask:0xf bank_mask:0xf
  v_and_b32_dpp v35, v62, v7 row_newbcast:0 row_mask:0xf bank_mask:0xf
  s_nop 0
  s_waitcnt vmcnt(7)
  v_mfma_f32_16x16x32_bf16 v[28:31], v[32:35], v[176:179], v[28:31]
  v_and_b32_dpp v36, v62, v4 row_newbcast:4 row_mask:0xf bank_mask:0xf
  v_and_b32_dpp v37, v62, v5 row_newbcast:4 row_mask:0xf bank_mask:0xf
  v_and_b32_dpp v38, v62, v6 row_newbcast:4 row_mask:0xf bank_mask:0xf
  v_and_b32_dpp v39, v62, v7 row_newbcast:4 row_mask:0xf bank_mask:0xf
  s_nop 0
  s_waitcnt vmcnt(6)
  v_mfma_f32_16x16x32_bf16 v[28:31], v[36:39], v[180:183], v[28:31]
  v_and_b32_dpp v32, v62, v4 row_newbcast:8 row_mask:0xf bank_mask:0xf
  v_and_b32_dpp v33, v62, v5 row_newbcast:8 row_mask:0xf bank_mask:0xf
  v_and_b32_dpp v34, v62, v6 row_newbcast:8 row_mask:0xf bank_mask:0xf
  v_and_b32_dpp v35, v62, v7 row_newbcast:8 row_mask:0xf bank_mask:0xf
  s_nop 0
  s_waitcnt vmcnt(5)
  v_mfma_f32_16x16x32_bf16 v[28:31], v[32:35], v[184:187], v[28:31]
  v_and_b32_dpp v36, v62, v4 row_newbcast:12 row_mask:0xf bank_mask:0xf
  v_and_b32_dpp v37, v62, v5 row_newbcast:12 row_mask:0xf bank_mask:0xf
  v_and_b32_dpp v38, v62, v6 row_newbcast:12 row_mask:0xf bank_mask:0xf
  v_and_b32_dpp v39, v62, v7 row_newbcast:12 row_mask:0xf bank_mask:0xf
  s_nop 0
  s_waitcnt vmcnt(4)
  v_mfma_f32_16x16x32_bf16 v[28:31], v[36:39], v[188:191], v[28:31]
  v_and_b32_dpp v32, v63, v4 row_newbcast:0 row_mask:0xf bank_mask:0xf
  v_and_b32_dpp v33, v63, v5 row_newbcast:0 row_mask:0xf bank_mask:0xf
  v_and_b32_dpp v34, v63, v6 row_newbcast:0 row_mask:0xf bank_mask:0xf
  v_and_b32_dpp v35, v63, v7 row_newbcast:0 row_mask:0xf bank_mask:0xf
  s_nop 0
  s_waitcnt vmcnt(3)
  v_mfma_f32_16x16x32_bf16 v[28:31], v[32:35], v[192:195], v[28:31]
  v_and_b32_dpp v36, v63, v4 row_newbcast:4 row_mask:0xf bank_mask:0xf
  v_and_b32_dpp v37, v63, v5 row_newbcast:4 row_mask:0xf bank_mask:0xf
  v_and_b32_dpp v38, v63, v6 row_newbcast:4 row_mask:0xf bank_mask:0xf
  v_and_b32_dpp v39, v63, v7 row_newbcast:4 row_mask:0xf bank_mask:0xf
  s_nop 0
  s_waitcnt vmcnt(2)
  v_mfma_f32_16x16x32_bf16 v[28:31], v[36:39], v[196:199], v[28:31]
  v_and_b32_dpp v32, v63, v4 row_newbcast:8 row_mask:0xf bank_mask:0xf
  v_and_b32_dpp v33, v63, v5 row_newbcast:8 row_mask:0xf bank_mask:0xf
  v_and_b32_dpp v34, v63, v6 row_newbcast:8 row_mask:0xf bank_mask:0xf
  v_and_b32_dpp v35, v63, v7 row_newbcast:8 row_mask:0xf bank_mask:0xf
  s_nop 0
  s_waitcnt vmcnt(1)
  v_mfma_f32_16x16x32_bf16 v[28:31], v[32:35], v[200:203], v[28:31]
  v_and_b32_dpp v36, v63, v4 row_newbcast:12 row_mask:0xf bank_mask:0xf
  v_and_b32_dpp v37, v63, v5 row_newbcast:12 row_mask:0xf bank_mask:0xf
  v_and_b32_dpp v38, v63, v6 row_newbcast:12 row_mask:0xf bank_mask:0xf
  v_and_b32_dpp v39, v63, v7 row_newbcast:12 row_mask:0xf bank_mask:0xf
  s_nop 0
  s_waitcnt vmcnt(0)
  v_mfma_f32_16x16x32_bf16 v[28:31], v[36:39], v[204:207], v[28:31]
  s_mov_b32 exec_hi, 0
  s_cmp_eq_u32 s70, 7
  s_cselect_b32 s37, 3, 7
  s_mov_b32 exec_lo, 1
  buffer_store_byte v26, v26, s[56:59], s96 offen
  s_mov_b32 exec_lo, -1
  s_nop 1
  ds_write_b128 v10, v[28:31] offset:1024
  s_mov_b32 exec_lo, 1
  ds_add_rtn_u32 v25, v26, v27 offset:0
  s_mov_b32 exec_lo, -1
  ds_read_b128 v[48:51], v8 offset:1024
  ds_read_b128 v[52:55], v8 offset:1536
  ds_read_b128 v[56:59], v8 offset:2048
  ds_read_b128 v[60:63], v8 offset:2560
  s_waitcnt lgkmcnt(3)
  v_readfirstlane_b32 s36, v25
  v_pk_mul_f32 v[48:49], v[48:49], v[40:41] op_sel_hi:[1,0]
  v_pk_mul_f32 v[50:51], v[50:51], v[40:41] op_sel_hi:[1,0]
  s_waitcnt lgkmcnt(2)
  v_pk_fma_f32 v[48:49], v[52:53], v[40:41], v[48:49] op_sel:[0,1,0]
  v_pk_fma_f32 v[50:51], v[54:55], v[40:41], v[50:51] op_sel:[0,1,0]
  s_waitcnt lgkmcnt(1)
  v_pk_fma_f32 v[48:49], v[56:57], v[42:43], v[48:49] op_sel_hi:[1,0,1]
  v_pk_fma_f32 v[50:51], v[58:59], v[42:43], v[50:51] op_sel_hi:[1,0,1]
  s_waitcnt lgkmcnt(0)
  v_pk_fma_f32 v[48:49], v[60:61], v[42:43], v[48:49] op_sel:[0,1,0]
  v_pk_fma_f32 v[50:51], v[62:63], v[42:43], v[50:51] op_sel:[0,1,0]
  s_cmp_eq_u32 s36, s37
  v_cvt_pk_bf16_f32 v48, v48, v49
  v_cvt_pk_bf16_f32 v49, v50, v51
  s_cbranch_scc0 L_pub_far
  buffer_store_dwordx2 v[48:49], v11, s[56:59], s62 offen
L_sdone:
  s_endpgm
L_pub_far:
  s_cmp_eq_u32 s36, 3
  s_cbranch_scc0 L_sdone
  buffer_store_dwordx2 v[48:49], v11, s[56:59], s62 offen sc1
  s_branch L_sdone
L_q2:
  s_cmp_eq_u32 s71, 0
  s_cbranch_scc0 L_tile
  s_and_b32 s68, s2, 7
  s_lshr_b32 s69, s2, 3
  s_getreg_b32 s63, hwreg(HW_REG_XCC_ID, 0, 3)
  s_or_b32 s63, s63, 0x80
  v_mov_b32 v27, 1
  s_cmp_lt_u32 s69, 30
  s_cselect_b32 s99, 2, 0
  s_cmp_eq_u32 s68, 2
  s_cselect_b32 s99, s99, 0
  s_cmp_lt_u32 s69, 8
  s_cselect_b32 s99, 1, s99
  v_and_b32 v10, 1, v2
  v_lshlrev_b32 v10, 4, v10
  v_mov_b32 v9, 0xffff
  v_lshlrev_b32 v10, v10, v9
  v_bfe_u32 v9, v2, 1, 2
  v_cmp_eq_u32 vcc, 0, v9
  s_nop 1
  v_cndmask_b32 v4, 0, v10, vcc
  v_cmp_eq_u32 vcc, 1, v9
  s_nop 1
  v_cndmask_b32 v5, 0, v10, vcc
  v_cmp_eq_u32 vcc, 2, v9
  s_nop 1
  v_cndmask_b32 v6, 0, v10, vcc
  v_cmp_eq_u32 vcc, 3, v9
  s_nop 1
  v_cndmask_b32 v7, 0, v10, vcc
  v_and_b32 v12, 31, v1
  v_lshlrev_b32 v12, 4, v12
  v_lshrrev_b32 v13, 5, v1
  v_lshl_add_u32 v60, v13, 10, v12
  s_lshl_b32 s97, s62, 10
  s_add_u32 s97, s97, 524288
  s_lshl_b32 s36, s31, 10
  s_lshl2_add_u32 s36, s34, s36
  s_add_u32 s36, s36, 393216
  v_lshl_add_u32 v61, v1, 7, s36
  v_and_b32 v132, 7, v1
  v_lshlrev_b32 v132, 2, v132
  v_mov_b32 v133, s63
  v_and_b32 v13, 1, v3
  v_lshlrev_b32 v13, 3, v13
  v_lshl_add_u32 v62, v2, 4, v13
  v_mov_b32 v56, 0
  v_mov_b32 v57, 0
  v_mov_b32 v58, 0
  v_mov_b32 v59, 0
  s_waitcnt vmcnt(18)
  v_and_b32 v33, 0xffff0000, v20
  v_lshlrev_b32 v32, 16, v20
  v_and_b32 v35, 0xffff0000, v21
  v_lshlrev_b32 v34, 16, v21
  v_and_b32 v37, 0xffff0000, v22
  v_lshlrev_b32 v36, 16, v22
  v_and_b32 v39, 0xffff0000, v23
  v_lshlrev_b32 v38, 16, v23
  v_and_b32 v41, 0xffff0000, v128
  v_lshlrev_b32 v40, 16, v128
  v_and_b32 v43, 0xffff0000, v129
  v_lshlrev_b32 v42, 16, v129
  v_and_b32 v45, 0xffff0000, v130
  v_lshlrev_b32 v44, 16, v130
  v_and_b32 v47, 0xffff0000, v131
  v_lshlrev_b32 v46, 16, v131
  v_pk_add_f32 v[48:49], v[32:33], v[34:35]
  v_pk_add_f32 v[50:51], v[36:37], v[38:39]
  v_pk_add_f32 v[52:53], v[40:41], v[42:43]
  v_pk_add_f32 v[54:55], v[44:45], v[46:47]
  v_pk_add_f32 v[48:49], v[48:49], v[50:51]
  v_pk_add_f32 v[52:53], v[52:53], v[54:55]
  v_pk_add_f32 v[48:49], v[48:49], v[52:53]
  v_add_f32 v28, v48, v49
  s_nop 1
  v_add_f32_dpp v28, v28, v28 quad_perm:[1,0,3,2] row_mask:0xf bank_mask:0xf
  s_nop 1
  v_add_f32_dpp v28, v28, v28 quad_perm:[2,3,0,1] row_mask:0xf bank_mask:0xf
  s_nop 1
  v_add_f32_dpp v28, v28, v28 row_ror:4 row_mask:0xf bank_mask:0xf
  s_nop 1
  v_add_f32_dpp v28, v28, v28 row_ror:8 row_mask:0xf bank_mask:0xf
  v_mov_b32 v29, v28
  s_nop 1
  v_permlane16_swap_b32 v28, v29
  v_add_f32 v28, v28, v29
  v_mul_f32 v28, 0x3b000000, v28
  v_pk_add_f32 v[32:33], v[32:33], v[28:29] op_sel_hi:[1,0] neg_lo:[0,1] neg_hi:[0,1]
  v_pk_add_f32 v[34:35], v[34:35], v[28:29] op_sel_hi:[1,0] neg_lo:[0,1] neg_hi:[0,1]
  v_pk_add_f32 v[36:37], v[36:37], v[28:29] op_sel_hi:[1,0] neg_lo:[0,1] neg_hi:[0,1]
  v_pk_add_f32 v[38:39], v[38:39], v[28:29] op_sel_hi:[1,0] neg_lo:[0,1] neg_hi:[0,1]
  v_pk_add_f32 v[40:41], v[40:41], v[28:29] op_sel_hi:[1,0] neg_lo:[0,1] neg_hi:[0,1]
  v_pk_add_f32 v[42:43], v[42:43], v[28:29] op_sel_hi:[1,0] neg_lo:[0,1] neg_hi:[0,1]
  v_pk_add_f32 v[44:45], v[44:45], v[28:29] op_sel_hi:[1,0] neg_lo:[0,1] neg_hi:[0,1]
  v_pk_add_f32 v[46:47], v[46:47], v[28:29] op_sel_hi:[1,0] neg_lo:[0,1] neg_hi:[0,1]
  v_pk_mul_f32 v[30:31], v[32:33], v[32:33]
  v_pk_fma_f32 v[30:31], v[34:35], v[34:35], v[30:31]
  v_pk_fma_f32 v[30:31], v[36:37], v[36:37], v[30:31]
  v_pk_fma_f32 v[30:31], v[38:39], v[38:39], v[30:31]
  v_pk_fma_f32 v[30:31], v[40:41], v[40:41], v[30:31]
  v_pk_fma_f32 v[30:31], v[42:43], v[42:43], v[30:31]
  v_pk_fma_f32 v[30:31], v[44:45], v[44:45], v[30:31]
  v_pk_fma_f32 v[30:31], v[46:47], v[46:47], v[30:31]
  v_add_f32 v30, v30, v31
  s_nop 1
  v_add_f32_dpp v30, v30, v30 quad_perm:[1,0,3,2] row_mask:0xf bank_mask:0xf
  s_nop 1
  v_add_f32_dpp v30, v30, v30 quad_perm:[2,3,0,1] row_mask:0xf bank_mask:0xf
  s_nop 1
  v_add_f32_dpp v30, v30, v30 row_ror:4 row_mask:0xf bank_mask:0xf
  s_nop 1
  v_add_f32_dpp v30, v30, v30 row_ror:8 row_mask:0xf bank_mask:0xf
  v_mov_b32 v29, v30
  s_nop 1
  v_permlane16_swap_b32 v30, v29
  v_add_f32 v30, v30, v29
  v_mul_f32 v30, 0x3b000000, v30
  v_cvt_pk_bf16_f32 v30, v30, v30
  v_lshlrev_b32 v30, 16, v30
  v_add_f32 v30, 0x3727c5ac, v30
  v_cvt_pk_bf16_f32 v30, v30, v30
  v_lshlrev_b32 v30, 16, v30
  v_sqrt_f32 v30, v30
  v_cvt_pk_bf16_f32 v28, v28, v28
  v_lshlrev_b32 v28, 16, v28
  v_cvt_pk_bf16_f32 v30, v30, v30
  v_lshlrev_b32 v30, 16, v30
  v_rcp_f32 v30, v30
  v_mov_b32 v29, v28
  v_mov_b32 v31, v30
  s_nop 1
  v_permlane32_swap_b32 v28, v29
  v_permlane32_swap_b32 v30, v31
L_tile:
  s_waitcnt vmcnt(16)
  v_lshlrev_b32 v14, 16, v14
  v_lshlrev_b32 v15, 16, v15
  v_sub_f32 v14, v14, v28
  v_sub_f32 v15, v15, v29
  v_cvt_pk_bf16_f32 v14, v14, v14
  v_lshlrev_b32 v14, 16, v14
  v_cvt_pk_bf16_f32 v15, v15, v15
  v_lshlrev_b32 v15, 16, v15
  v_mul_f32 v14, v14, v30
  v_mul_f32 v15, v15, v31
  v_cvt_pk_bf16_f32 v14, v14, v14
  v_cvt_pk_bf16_f32 v15, v15, v15
  s_nop 0
  v_mov_b32_dpp v40, v14 row_newbcast:0 row_mask:0xf bank_mask:0x3
  v_mov_b32_dpp v40, v15 row_newbcast:0 row_mask:0xf bank_mask:0xc
  v_mov_b32_dpp v41, v14 row_newbcast:1 row_mask:0xf bank_mask:0x3
  v_mov_b32_dpp v41, v15 row_newbcast:1 row_mask:0xf bank_mask:0xc
  v_mov_b32_dpp v42, v14 row_newbcast:2 row_mask:0xf bank_mask:0x3
  v_mov_b32_dpp v42, v15 row_newbcast:2 row_mask:0xf bank_mask:0xc
  v_mov_b32_dpp v43, v14 row_newbcast:3 row_mask:0xf bank_mask:0x3
  v_mov_b32_dpp v43, v15 row_newbcast:3 row_mask:0xf bank_mask:0xc
  v_mov_b32_dpp v44, v14 row_newbcast:4 row_mask:0xf bank_mask:0x3
  v_mov_b32_dpp v44, v15 row_newbcast:4 row_mask:0xf bank_mask:0xc
  v_mov_b32_dpp v45, v14 row_newbcast:5 row_mask:0xf bank_mask:0x3
  v_mov_b32_dpp v45, v15 row_newbcast:5 row_mask:0xf bank_mask:0xc
  v_mov_b32_dpp v46, v14 row_newbcast:6 row_mask:0xf bank_mask:0x3
  v_mov_b32_dpp v46, v15 row_newbcast:6 row_mask:0xf bank_mask:0xc
  v_mov_b32_dpp v47, v14 row_newbcast:7 row_mask:0xf bank_mask:0x3
  v_mov_b32_dpp v47, v15 row_newbcast:7 row_mask:0xf bank_mask:0xc
  v_mov_b32_dpp v48, v14 row_newbcast:8 row_mask:0xf bank_mask:0x3
  v_mov_b32_dpp v48, v15 row_newbcast:8 row_mask:0xf bank_mask:0xc
  v_mov_b32_dpp v49, v14 row_newbcast:9 row_mask:0xf bank_mask:0x3
  v_mov_b32_dpp v49, v15 row_newbcast:9 row_mask:0xf bank_mask:0xc
  v_mov_b32_dpp v50, v14 row_newbcast:10 row_mask:0xf bank_mask:0x3
  v_mov_b32_dpp v50, v15 row_newbcast:10 row_mask:0xf bank_mask:0xc
  v_mov_b32_dpp v51, v14 row_newbcast:11 row_mask:0xf bank_mask:0x3
  v_mov_b32_dpp v51, v15 row_newbcast:11 row_mask:0xf bank_mask:0xc
  v_mov_b32_dpp v52, v14 row_newbcast:12 row_mask:0xf bank_mask:0x3
  v_mov_b32_dpp v52, v15 row_newbcast:12 row_mask:0xf bank_mask:0xc
  v_mov_b32_dpp v53, v14 row_newbcast:13 row_mask:0xf bank_mask:0x3
  v_mov_b32_dpp v53, v15 row_newbcast:13 row_mask:0xf bank_mask:0xc
  v_mov_b32_dpp v54, v14 row_newbcast:14 row_mask:0xf bank_mask:0x3
  v_mov_b32_dpp v54, v15 row_newbcast:14 row_mask:0xf bank_mask:0xc
  v_mov_b32_dpp v55, v14 row_newbcast:15 row_mask:0xf bank_mask:0x3
  v_mov_b32_dpp v55, v15 row_newbcast:15 row_mask:0xf bank_mask:0xc
  v_and_b32 v32, v40, v4
  v_and_b32 v33, v40, v5
  v_and_b32 v34, v40, v6
  v_and_b32 v35, v40, v7
  s_waitcnt vmcnt(15)
  s_nop 0
  v_mfma_f32_16x16x32_bf16 v[56:59], v[32:35], v[64:67], v[56:59]
  v_and_b32 v36, v41, v4
  v_and_b32 v37, v41, v5
  v_and_b32 v38, v41, v6
  v_and_b32 v39, v41, v7
  s_waitcnt vmcnt(14)
  s_nop 0
  v_mfma_f32_16x16x32_bf16 v[56:59], v[36:39], v[68:71], v[56:59]
  v_and_b32 v32, v42, v4
  v_and_b32 v33, v42, v5
  v_and_b32 v34, v42, v6
  v_and_b32 v35, v42, v7
  s_waitcnt vmcnt(13)
  s_nop 0
  v_mfma_f32_16x16x32_bf16 v[56:59], v[32:35], v[72:75], v[56:59]
  v_and_b32 v36, v43, v4
  v_and_b32 v37, v43, v5
  v_and_b32 v38, v43, v6
  v_and_b32 v39, v43, v7
  s_waitcnt vmcnt(12)
  s_nop 0
  v_mfma_f32_16x16x32_bf16 v[56:59], v[36:39], v[76:79], v[56:59]
  v_and_b32 v32, v44, v4
  v_and_b32 v33, v44, v5
  v_and_b32 v34, v44, v6
  v_and_b32 v35, v44, v7
  s_waitcnt vmcnt(11)
  s_nop 0
  v_mfma_f32_16x16x32_bf16 v[56:59], v[32:35], v[80:83], v[56:59]
  v_and_b32 v36, v45, v4
  v_and_b32 v37, v45, v5
  v_and_b32 v38, v45, v6
  v_and_b32 v39, v45, v7
  s_waitcnt vmcnt(10)
  s_nop 0
  v_mfma_f32_16x16x32_bf16 v[56:59], v[36:39], v[84:87], v[56:59]
  v_and_b32 v32, v46, v4
  v_and_b32 v33, v46, v5
  v_and_b32 v34, v46, v6
  v_and_b32 v35, v46, v7
  s_waitcnt vmcnt(9)
  s_nop 0
  v_mfma_f32_16x16x32_bf16 v[56:59], v[32:35], v[88:91], v[56:59]
  v_and_b32 v36, v47, v4
  v_and_b32 v37, v47, v5
  v_and_b32 v38, v47, v6
  v_and_b32 v39, v47, v7
  s_waitcnt vmcnt(8)
  s_nop 0
  v_mfma_f32_16x16x32_bf16 v[56:59], v[36:39], v[92:95], v[56:59]
  v_and_b32 v32, v48, v4
  v_and_b32 v33, v48, v5
  v_and_b32 v34, v48, v6
  v_and_b32 v35, v48, v7
  s_waitcnt vmcnt(7)
  s_nop 0
  v_mfma_f32_16x16x32_bf16 v[56:59], v[32:35], v[96:99], v[56:59]
  v_and_b32 v36, v49, v4
  v_and_b32 v37, v49, v5
  v_and_b32 v38, v49, v6
  v_and_b32 v39, v49, v7
  s_waitcnt vmcnt(6)
  s_nop 0
  v_mfma_f32_16x16x32_bf16 v[56:59], v[36:39], v[100:103], v[56:59]
  v_and_b32 v32, v50, v4
  v_and_b32 v33, v50, v5
  v_and_b32 v34, v50, v6
  v_and_b32 v35, v50, v7
  s_waitcnt vmcnt(5)
  s_nop 0
  v_mfma_f32_16x16x32_bf16 v[56:59], v[32:35], v[104:107], v[56:59]
  v_and_b32 v36, v51, v4
  v_and_b32 v37, v51, v5
  v_and_b32 v38, v51, v6
  v_and_b32 v39, v51, v7
  s_waitcnt vmcnt(4)
  s_nop 0
  v_mfma_f32_16x16x32_bf16 v[56:59], v[36:39], v[108:111], v[56:59]
  v_and_b32 v32, v52, v4
  v_and_b32 v33, v52, v5
  v_and_b32 v34, v52, v6
  v_and_b32 v35, v52, v7
  s_waitcnt vmcnt(3)
  s_nop 0
  v_mfma_f32_16x16x32_bf16 v[56:59], v[32:35], v[112:115], v[56:59]
  v_and_b32 v36, v53, v4
  v_and_b32 v37, v53, v5
  v_and_b32 v38, v53, v6
  v_and_b32 v39, v53, v7
  s_waitcnt vmcnt(2)
  s_nop 0
  v_mfma_f32_16x16x32_bf16 v[56:59], v[36:39], v[116:119], v[56:59]
  v_and_b32 v32, v54, v4
  v_and_b32 v33, v54, v5
  v_and_b32 v34, v54, v6
  v_and_b32 v35, v54, v7
  s_waitcnt vmcnt(1)
  s_nop 0
  v_mfma_f32_16x16x32_bf16 v[56:59], v[32:35], v[120:123], v[56:59]
  v_and_b32 v36, v55, v4
  v_and_b32 v37, v55, v5
  v_and_b32 v38, v55, v6
  v_and_b32 v39, v55, v7
  s_waitcnt vmcnt(0)
  s_nop 0
  v_mfma_f32_16x16x32_bf16 v[56:59], v[36:39], v[124:127], v[56:59]
  s_cmp_eq_u32 s71, 0
  ds_write_b32 v26, v27 offset:80
  s_nop 4
  s_cbranch_scc0 L_qmore
  buffer_store_dwordx4 v[56:59], v8, s[56:59], s97 offen
  s_lshl_b32 s36, s31, 13
  s_lshl_b32 s37, s32, 9
  s_add_u32 s36, s36, s37
  s_add_u32 s36, s36, 524288
  s_add_u32 s37, s36, 4096
  s_mov_b64 exec, 0xff
  s_waitcnt vmcnt(0)
  buffer_store_dword v133, v61, s[56:59], 0 offen
  s_mov_b64 exec, -1
  s_mov_b32 s61, 32
  s_branch L_pollQ
L_pollQ_r:
  s_sub_u32 s61, s61, 1
  s_cbranch_scc1 L_qfail
  s_mov_b64 exec, vcc
L_pollQ:
  buffer_load_dword v32, v132, s[56:59], s96 offen sc1
  s_mov_b64 exec, -1
  s_waitcnt vmcnt(0)
  v_cmp_eq_u32 vcc, -1, v32
  s_cbranch_vccnz L_pollQ_r
L_pollQ_x:
  v_cmp_ne_u32 vcc, v32, v133
  s_cbranch_vccnz L_qfail
  buffer_load_dwordx4 v[32:35], v60, s[56:59], s36 offen offset:0 sc1
  buffer_load_dwordx4 v[36:39], v60, s[56:59], s36 offen offset:2048 sc1
  buffer_load_dwordx4 v[40:43], v60, s[56:59], s37 offen offset:0 sc1
  buffer_load_dwordx4 v[44:47], v60, s[56:59], s37 offen offset:2048 sc1
  s_waitcnt vmcnt(0)
  v_pk_add_f32 v[32:33], v[32:33], v[36:37]
  v_pk_add_f32 v[34:35], v[34:35], v[38:39]
  v_pk_add_f32 v[40:41], v[40:41], v[44:45]
  v_pk_add_f32 v[42:43], v[42:43], v[46:47]
  v_pk_add_f32 v[32:33], v[32:33], v[40:41]
  v_pk_add_f32 v[34:35], v[34:35], v[42:43]
  v_mov_b32 v36, v32
  v_mov_b32 v37, v33
  v_mov_b32 v38, v34
  v_mov_b32 v39, v35
  v_permlane32_swap_b32 v32, v36
  v_permlane32_swap_b32 v33, v37
  v_permlane32_swap_b32 v34, v38
  v_permlane32_swap_b32 v35, v39
  v_pk_add_f32 v[56:57], v[32:33], v[36:37]
  v_pk_add_f32 v[58:59], v[34:35], v[38:39]
L_qput:
  v_cvt_pk_bf16_f32 v32, v56, v57
  v_cvt_pk_bf16_f32 v33, v58, v59
  ds_write_b64 v62, v[32:33] offset:224
  ds_write_b32 v26, v27 offset:64
  s_mov_b64 exec, -1
  s_setprio 0
  s_lshl_b32 s62, s62, 9
L_locQ:
  ds_read_b32 v12, v26 offset:192
  s_sleep 4
  s_waitcnt vmcnt(0) lgkmcnt(0)
  v_readfirstlane_b32 s70, v12
  s_cmp_eq_u32 s70, 0
  s_cbranch_scc1 L_locQ
L_waitst:
  ds_read_b32 v12, v26 offset:16
  s_sleep 8
  s_waitcnt lgkmcnt(0)
  v_cmp_ne_u32 vcc, 4, v12
  s_cbranch_vccnz L_waitst
  ds_read_b128 v[12:15], v26 offset:480
  ds_read_b128 v[16:19], v26 offset:496
  s_waitcnt lgkmcnt(0)
  v_max3_f32 v20, v12, v14, v16
  v_max_f32 v20, v20, v18
  v_sub_f32 v28, v12, v20
  v_sub_f32 v29, v14, v20
  v_sub_f32 v30, v16, v20
  v_sub_f32 v31, v18, v20
  v_exp_f32 v28, v28
  v_exp_f32 v29, v29
  v_exp_f32 v30, v30
  v_exp_f32 v31, v31
  v_mov_b32 v12, s70
  v_mul_f32 v21, v28, v13
  v_fmac_f32 v21, v29, v15
  v_fmac_f32 v21, v30, v17
  v_fmac_f32 v21, v31, v19
  v_rcp_f32 v13, v21
  v_lshrrev_b32 v14, 1, v8
  s_mov_b64 exec, 0xffff
  s_cmp_eq_u32 s70, 7
  s_cbranch_scc1 L_st_loc
  buffer_store_dwordx2 v[20:21], v14, s[56:59], s62 offen offset:256 sc1
  s_branch L_st_done
L_st_loc:
  buffer_store_dwordx2 v[20:21], v14, s[56:59], s62 offen offset:256
L_st_done:
  v_mul_f32 v28, v28, v13
  v_mul_f32 v29, v29, v13
  v_mul_f32 v30, v30, v13
  v_mul_f32 v31, v31, v13
  ds_write_b128 v26, v[28:31] offset:144
  ds_write_b32 v26, v12 offset:128
  s_mov_b64 exec, -1
  s_cmp_eq_u32 s99, 0
  s_cbranch_scc1 L_fin
  s_branch L_role
L_qfail:
  s_mov_b32 s71, 8
L_qmore:
  s_and_b32 s60, s60, 0x3fffff
  s_sub_u32 s71, s71, 1
  s_cmp_eq_u32 s71, 0
  s_cbranch_scc0 L_qload
  s_lshl_b32 s36, s32, 5
  s_bfm_b64 exec, 32, s36
  s_branch L_qput
L_other:
  s_and_b32 s68, s2, 7
  s_lshr_b32 s69, s2, 3
  s_getreg_b32 s63, hwreg(HW_REG_XCC_ID, 0, 3)
  s_or_b32 s63, s63, 0x80
  v_mov_b32 v27, 1
  s_cmp_lt_u32 s69, 30
  s_cselect_b32 s99, 2, 0
  s_cmp_eq_u32 s68, 2
  s_cselect_b32 s99, s99, 0
  s_cmp_lt_u32 s69, 8
  s_cselect_b32 s99, 1, s99
  s_cmp_eq_u32 s35, 3
  s_cbranch_scc0 L_nokeep
  s_cmp_lt_u32 s69, 3
  s_cbranch_scc0 L_nocp
  s_getpc_b64 s[38:39]
L_pc:
  s_sub_u32 s38, s38, L_pc-sequential_preLN__mha_block_cached__dense_activation_squared_relu__decode_kernel
  s_subb_u32 s39, s39, 0
  s_lshl_b32 s36, s69, 13
  v_lshl_add_u32 v28, v1, 7, s36
  v_min_u32 v28, L_end-sequential_preLN__mha_block_cached__dense_activation_squared_relu__decode_kernel, v28
  global_load_dword v248, v28, s[38:39]
L_nocp:
  s_lshl_b32 s67, s68, 7
  s_add_u32 s67, s67, 425984
  v_and_b32 v30, 31, v1
  v_lshlrev_b32 v30, 2, v30
  s_cmp_eq_u32 s69, 31
  s_cbranch_scc0 L_nohc
  v_mov_b32 v31, -1
  buffer_store_dword v31, v30, s[56:59], s67 offen
L_nohc:
  s_mov_b32 s97, 4
L_ck0:
  ds_read_b32 v12, v26 offset:160
  s_sleep 2
  v_mov_b32 v25, 1
  s_waitcnt lgkmcnt(0)
  v_cmp_gt_u32 vcc, s97, v12
  s_cbranch_vccnz L_ck0
  s_mov_b32 s61, 400000
  v_lshrrev_b32 v13, 1, v2
  v_lshlrev_b32 v13, 5, v13
  v_and_b32 v14, 1, v2
  v_lshl_add_u32 v13, v14, 2, v13
L_cnt:
  global_load_dword v12, v13, s[26:27] sc1
  s_waitcnt vmcnt(0)
  s_mov_b32 s36, 0x80808080
  s_mul_i32 s37, s63, 0x01010101
  v_and_b32 v14, s36, v12
  v_cmp_eq_u32 s[38:39], s37, v12
  v_cmp_ne_u32 vcc, s36, v14
  s_lshl_b32 s36, s68, 1
  s_lshr_b32 s70, s38, s36
  s_and_b32 s70, s70, 3
  s_or_b32 s70, s70, 4
  s_and_b32 s71, vcc_lo, 0xffff
  s_cbranch_scc0 L_cnt_x
  s_sleep 16
  s_sub_u32 s61, s61, 4
  s_cbranch_scc0 L_cnt
L_cnt_x:
  v_mov_b32 v12, s70
  ds_write_b32 v26, v12 offset:192
  s_and_b32 s96, s69, 7
  s_lshl_b32 s96, s96, 9
  s_cmp_eq_u32 s99, 1
  s_cselect_b32 s98, 1, 0
  s_cmp_eq_u32 s68, 2
  s_cselect_b32 s98, 6, s98
  s_cselect_b32 s66, -64, 11
  s_cmp_eq_u32 s99, 2
  s_cselect_b32 s98, 11, s98
  s_mov_b32 s97, 8
  s_mov_b64 exec, 1
L_ck:
  ds_read_b32 v12, v26 offset:160
  s_sleep 2
  v_mov_b32 v25, 1
  s_waitcnt lgkmcnt(0)
  v_cmp_gt_u32 vcc, s97, v12
  s_cbranch_vccnz L_ck
  buffer_atomic_add v25, v26, s[56:59], s96 offen offset:384 sc0 sc1
  s_add_u32 s96, s96, 4096
  s_waitcnt vmcnt(0)
  v_readfirstlane_b32 s37, v25
  s_sub_i32 s36, s37, 15
  s_max_i32 s36, s36, 0
  s_mul_i32 s36, s36, s36
  s_lshr_b32 s36, s36, 3
  s_add_u32 s36, s36, s98
  s_min_u32 s36, s36, 32
  s_bfm_b64 s[38:39], s36, 0
  v_mov_b32 v14, s38
  s_sub_i32 s36, s66, s37
  s_max_i32 s36, s36, 0
  s_mul_i32 s36, s36, s36
  s_lshr_b32 s36, s36, 4
  s_min_u32 s36, s36, 32
  s_bfm_b64 s[38:39], s36, 0
  v_mov_b32 v15, s38
  ds_write2_b32 v26, v14, v15 offset0:44 offset1:52
  s_add_u32 s97, s97, 4
  s_cmp_le_u32 s97, 16
  s_cbranch_scc1 L_ck
  s_mov_b64 exec, -1
  s_cmp_eq_u32 s69, 31
  s_cbranch_scc0 L_nokeep
L_htr:
  ds_read_b32 v12, v26 offset:96
  s_sleep 2
  s_waitcnt lgkmcnt(0)
  v_cmp_ne_u32 vcc, 1, v12
  s_cbranch_vccnz L_htr
  s_cmp_eq_u32 s70, 7
  s_cselect_b32 s61, 160, 0
  s_lshl_b32 s36, s68, 9
  s_add_u32 s36, s36, 33152
L_her:
  buffer_load_dword v31, v30, s[56:59], s67 offen sc1
  s_sub_u32 s61, s61, 1
  s_cbranch_scc1 L_her_x
  s_waitcnt vmcnt(0)
  v_cmp_ne_u32 vcc, 0, v31
  s_cbranch_vccnz L_her
L_her_x:
  s_mov_b64 exec, 1
  buffer_store_dword v26, v26, s[56:59], s36 offen sc1
  s_mov_b64 exec, -1
L_nokeep:
  s_cmp_eq_u32 s99, 0
  s_cbranch_scc1 L_fin
  s_mov_b64 s[40:41], s[4:5]
  s_mov_b32 s42, 2048
  s_mov_b32 s43, 0x20000
  v_and_b32 v10, 1, v2
  v_lshlrev_b32 v10, 4, v10
  v_mov_b32 v9, 0xffff
  v_lshlrev_b32 v10, v10, v9
  v_bfe_u32 v9, v2, 1, 2
  v_cmp_eq_u32 vcc, 0, v9
  s_nop 1
  v_cndmask_b32 v4, 0, v10, vcc
  v_cmp_eq_u32 vcc, 1, v9
  s_nop 1
  v_cndmask_b32 v5, 0, v10, vcc
  v_cmp_eq_u32 vcc, 2, v9
  s_nop 1
  v_cndmask_b32 v6, 0, v10, vcc
  v_cmp_eq_u32 vcc, 3, v9
  s_nop 1
  v_cndmask_b32 v7, 0, v10, vcc
  s_cmp_eq_u32 s35, 2
  s_cbranch_scc0 L_role
L_sign:
  s_lshl_b32 s36, s68, 5
  s_add_u32 s36, s36, s69
  s_lshl_b32 s37, s69, 3
  s_lshl_b32 s37, s63, s37
  s_and_b32 s36, s36, -4
  v_mov_b32 v12, s36
  v_mov_b32 v13, s37
  s_waitcnt vmcnt(0)
  s_mov_b64 exec, 1
  global_atomic_or v12, v13, s[26:27] sc1
  s_mov_b64 exec, -1
L_role:
  s_setprio 1
L_ldw:
  ds_read_b32 v12, v26 offset:80
  s_sleep 4
  s_waitcnt lgkmcnt(0)
  v_cmp_ne_u32 vcc, 1, v12
  s_cbranch_vccnz L_ldw
  s_cmp_eq_u32 s99, 2
  s_cbranch_scc1 L_roleF
  s_lshl_b32 s97, s69, 7
  s_cmp_eq_u32 s35, 1
  s_cbranch_scc0 L_Oset
  s_lshl_b32 s36, s68, 17
  s_add_u32 s36, s36, s97
  s_add_u32 s48, s12, s36
  s_addc_u32 s49, s13, 0
  s_mov_b32 s50, 3275904
  s_mov_b32 s51, 0x20000
  v_lshrrev_b32 v12, 3, v1
  v_and_b32 v13, 7, v1
  v_lshlrev_b32 v12, 10, v12
  v_lshl_add_u32 v12, v13, 4, v12
  s_mov_b32 s60, 0
  s_mov_b32 s39, 9216
L_ldO:
  s_mov_b32 m0, s39
  s_waitcnt vmcnt(4)
  buffer_load_dwordx4 v12, s[48:51], s60 offen nt lds
  s_add_u32 s60, s60, 0x2000
  s_bitcmp1_b32 s60, 17
  s_cselect_b32 s36, 917504, 0
  s_add_u32 s60, s60, s36
  s_add_u32 s39, s39, 1024
  s_cmp_lt_u32 s39, 74752
  s_cbranch_scc1 L_ldO
  s_waitcnt vmcnt(0)
  ds_write_b32 v26, v27 offset:32
L_Oset:
  s_lshl3_add_u32 s96, s35, s68
  s_lshl_b32 s96, s96, 12
  v_bfe_u32 v13, v1, 3, 1
  v_bfe_u32 v12, v1, 2, 1
  v_lshl_add_u32 v13, v13, 4, v12
  v_lshrrev_b32 v23, 1, v3
  v_lshl_add_u32 v13, v23, 5, v13
  v_and_b32 v24, 1, v3
  v_lshl_add_u32 v13, v24, 3, v13
  v_and_b32 v12, 3, v1
  v_lshlrev_b32 v12, 3, v12
  v_lshl_add_u32 v13, v13, 7, v12
  s_lshl_b32 s39, s35, 14
  v_add_u32 v13, s39, v13
L_stgO:
  ds_read_b32 v12, v26 offset:32
  s_sleep 4
  s_waitcnt lgkmcnt(0)
  v_cmp_ne_u32 vcc, 1, v12
  s_cbranch_vccnz L_stgO
  ds_read_b64_tr_b16 v[64:65], v13 offset:9216
  ds_read_b64_tr_b16 v[66:67], v13 offset:9472
  ds_read_b64_tr_b16 v[68:69], v13 offset:17408
  ds_read_b64_tr_b16 v[70:71], v13 offset:17664
  ds_read_b64_tr_b16 v[72:73], v13 offset:9728
  ds_read_b64_tr_b16 v[74:75], v13 offset:9984
  ds_read_b64_tr_b16 v[76:77], v13 offset:17920
  ds_read_b64_tr_b16 v[78:79], v13 offset:18176
  s_waitcnt lgkmcnt(0)
  ds_read_b64_tr_b16 v[80:81], v13 offset:9248
  ds_read_b64_tr_b16 v[82:83], v13 offset:9504
  ds_read_b64_tr_b16 v[84:85], v13 offset:17440
  ds_read_b64_tr_b16 v[86:87], v13 offset:17696
  ds_read_b64_tr_b16 v[88:89], v13 offset:9760
  ds_read_b64_tr_b16 v[90:91], v13 offset:10016
  ds_read_b64_tr_b16 v[92:93], v13 offset:17952
  ds_read_b64_tr_b16 v[94:95], v13 offset:18208
  s_waitcnt lgkmcnt(0)
  ds_read_b64_tr_b16 v[96:97], v13 offset:9280
  ds_read_b64_tr_b16 v[98:99], v13 offset:9536
  ds_read_b64_tr_b16 v[100:101], v13 offset:17472
  ds_read_b64_tr_b16 v[102:103], v13 offset:17728
  ds_read_b64_tr_b16 v[104:105], v13 offset:9792
  ds_read_b64_tr_b16 v[106:107], v13 offset:10048
  ds_read_b64_tr_b16 v[108:109], v13 offset:17984
  ds_read_b64_tr_b16 v[110:111], v13 offset:18240
  s_waitcnt lgkmcnt(0)
  ds_read_b64_tr_b16 v[112:113], v13 offset:9312
  ds_read_b64_tr_b16 v[114:115], v13 offset:9568
  ds_read_b64_tr_b16 v[116:117], v13 offset:17504
  ds_read_b64_tr_b16 v[118:119], v13 offset:17760
  ds_read_b64_tr_b16 v[120:121], v13 offset:9824
  ds_read_b64_tr_b16 v[122:123], v13 offset:10080
  ds_read_b64_tr_b16 v[124:125], v13 offset:18016
  ds_read_b64_tr_b16 v[126:127], v13 offset:18272
  s_waitcnt lgkmcnt(0)
  v_lshrrev_b32 v10, 1, v2
  v_lshlrev_b32 v10, 9, v10
  v_and_b32 v11, 1, v2
  v_lshl_add_u32 v10, v11, 4, v10
  v_lshl_add_u32 v10, v3, 5, v10
  v_mul_u32_u24 v22, 0xaaaa, v11
  v_add_u32 v22, 0x4444, v22
  s_lshl_b32 s38, s35, 10
  v_add_u32 v11, s38, v8
  v_lshlrev_b32 v21, 10, v23
  v_and_b32 v12, 31, v1
  v_lshl_add_u32 v21, v12, 2, v21
  v_lshlrev_b32 v23, 11, v23
  s_lshl_b32 s38, s68, 11
  s_add_u32 s38, s38, s97
  s_add_u32 s66, s38, 131072
L_locO:
  ds_read_b32 v12, v26 offset:192
  s_sleep 4
  s_waitcnt vmcnt(0) lgkmcnt(0)
  v_readfirstlane_b32 s70, v12
  s_cmp_eq_u32 s70, 0
  s_cbranch_scc1 L_locO
  s_mov_b32 s98, 3
  s_cmp_eq_u32 s68, 2
  s_cbranch_scc0 L_noR
  v_and_b32 v14, 7, v1
  v_lshlrev_b32 v13, 2, v14
  global_load_dword v15, v13, s[26:27] offset:64 sc1
  s_mul_i32 s39, s63, 0x01010101
  s_lshl2_add_u32 s36, s69, s35
  s_lshl_b32 s37, s36, 7
  s_add_u32 s37, s37, 147456
  s_add_u32 s52, s28, s37
  s_addc_u32 s53, s29, 0
  s_mov_b32 s54, 86144
  s_mov_b32 s55, 0x20000
  s_lshr_b32 s36, s69, 1
  s_lshl_b32 s36, s36, 8
  s_and_b32 s67, s69, 1
  s_lshl_b32 s37, s67, 6
  s_add_u32 s37, s37, s36
  s_lshl4_add_u32 s37, s35, s37
  v_bfe_u32 v12, v1, 4, 1
  v_lshlrev_b32 v12, 7, v12
  v_lshl_add_u32 v12, v14, 1, v12
  v_add_u32 v12, s37, v12
  v_lshrrev_b32 v13, 5, v1
  v_lshl_add_u32 v130, v13, 10, v12
  s_mov_b64 s[48:49], s[22:23]
  s_mov_b32 s50, 1024
  s_mov_b32 s51, 0x20000
  s_mov_b64 s[44:45], s[24:25]
  s_mov_b32 s46, 2048
  s_mov_b32 s47, 0x20000
  buffer_load_ushort v128, v130, s[40:43], 0 offen
  buffer_load_ushort v129, v12, s[48:51], 0 offen
  buffer_load_ushort v16, v130, s[44:47], 0 offen
  v_lshrrev_b32 v12, 3, v1
  v_lshlrev_b32 v13, 11, v12
  v_lshl_add_u32 v13, v14, 2, v13
  s_lshl_b32 s38, s35, 5
  s_add_u32 s36, s36, s38
  s_add_u32 s36, s36, 131072
  v_add_u32 v131, s36, v13
  s_lshl_b32 s67, s67, 4
  s_sub_u32 s67, 16, s67
  v_lshlrev_b32 v12, 12, v12
  v_lshl_add_u32 v132, v14, 4, v12
  v_add_u32 v133, 32768, v132
  v_add_u32 v134, 65536, v132
  v_cmp_eq_u32 vcc, 7, v14
  v_mov_b32 v13, 16
  s_waitcnt vmcnt(0)
  v_cndmask_b32 v13, 0, v13, vcc
  v_xor_b32 v15, s39, v15
  v_lshlrev_b32 v15, v13, v15
  v_cmp_ne_u32 vcc, 0, v15
  v_lshlrev_b32 v128, 16, v128
  v_lshlrev_b32 v129, 16, v129
  s_cbranch_vccnz L_noR
  s_mov_b32 s98, 7
L_noR:
  s_mov_b32 s61, 400000
  s_branch L_pollOs
L_pollOs_r:
  s_sub_u32 s61, s61, 1
  s_cbranch_scc1 L_pollOs_x
  s_sleep 24
  s_mov_b64 exec, vcc
L_pollOs:
  buffer_load_dwordx2 v[12:13], v23, s[56:59], s96 offen offset:256 sc1
  buffer_load_dwordx2 v[14:15], v23, s[56:59], s96 offen offset:768 sc1
  buffer_load_dwordx2 v[16:17], v23, s[56:59], s96 offen offset:1280 sc1
  buffer_load_dwordx2 v[18:19], v23, s[56:59], s96 offen offset:1792 sc1
  s_mov_b64 exec, -1
  s_waitcnt vmcnt(0)
  v_max3_u32 v20, v12, v13, v14
  v_max3_u32 v20, v20, v15, v16
  v_max3_u32 v20, v20, v17, v18
  v_max_u32 v20, v20, v19
  v_cmp_eq_u32 vcc, -1, v20
  s_cbranch_vccnz L_pollOs_r
L_pollOs_x:
  v_max3_f32 v20, v12, v14, v16
  v_max_f32 v20, v20, v18
  v_sub_f32 v28, v12, v20
  v_sub_f32 v29, v14, v20
  v_sub_f32 v30, v16, v20
  v_sub_f32 v31, v18, v20
  v_exp_f32 v28, v28
  v_exp_f32 v29, v29
  v_exp_f32 v30, v30
  v_exp_f32 v31, v31
  v_cmp_eq_u32 vcc, 1, v24
  v_mul_f32 v28, v28, v13
  v_mul_f32 v29, v29, v15
  v_mul_f32 v30, v30, v17
  v_mul_f32 v31, v31, v19
  v_add_f32 v20, v28, v29
  v_add_f32 v12, v30, v31
  v_add_f32 v20, v20, v12
  v_rcp_f32 v20, v20
  v_mov_b32 v40, 0
  v_mov_b32 v41, 0
  v_mov_b32 v42, 0
  v_mov_b32 v43, 0
  v_mov_b32 v44, 0
  v_mov_b32 v45, 0
  v_mov_b32 v46, 0
  v_mov_b32 v47, 0
  v_cndmask_b32 v28, v28, v30, vcc
  v_cndmask_b32 v29, v29, v31, vcc
  v_mul_f32 v28, v28, v20
  v_mul_f32 v29, v29, v20
L_trig:
  ds_read_b32 v12, v26 offset:96
  s_sleep 2
  s_waitcnt lgkmcnt(0)
  v_cmp_ne_u32 vcc, 1, v12
  s_cbranch_vccnz L_trig
  s_mov_b32 s61, 400000
  s_branch L_pollO
L_pollO_r:
  s_sub_u32 s61, s61, 1
  s_cbranch_scc1 L_pollO_x
  s_mov_b64 exec, vcc
L_pollO:
  buffer_load_dwordx4 v[12:15], v10, s[56:59], s96 offen offset:0 sc1
  buffer_load_dwordx4 v[16:19], v10, s[56:59], s96 offen offset:128 sc1
  s_mov_b64 exec, -1
  s_nop 1
  v_mov_b32 v32, 0
  v_mov_b32 v33, 0
  v_mov_b32 v34, 0
  v_mov_b32 v35, 0
  v_mov_b32 v36, 0
  v_mov_b32 v37, 0
  v_mov_b32 v38, 0
  v_mov_b32 v39, 0
  s_nop 0
  s_waitcnt vmcnt(0)
  v_smfmac_f32_16x16x64_bf16 v[32:35], v[12:15], v[64:71], v22
  v_max3_u32 v20, v12, v13, v14
  v_max3_u32 v20, v20, v15, v16
  v_smfmac_f32_16x16x64_bf16 v[32:35], v[16:19], v[72:79], v22
  v_max3_u32 v20, v20, v17, v18
  v_max_u32 v20, v20, v19
  v_smfmac_f32_16x16x64_bf16 v[36:39], v[12:15], v[80:87], v22
  v_cmp_eq_u32 vcc, -1, v20
  v_smfmac_f32_16x16x64_bf16 v[36:39], v[16:19], v[88:95], v22
  s_cbranch_vccnz L_pollO_r
L_pollO_x:
  v_smfmac_f32_16x16x64_bf16 v[40:43], v[12:15], v[96:103], v22
  v_smfmac_f32_16x16x64_bf16 v[40:43], v[16:19], v[104:111], v22
  v_pk_mul_f32 v[32:33], v[32:33], v[28:29] op_sel_hi:[1,0]
  v_smfmac_f32_16x16x64_bf16 v[44:47], v[12:15], v[112:119], v22
  v_pk_fma_f32 v[32:33], v[34:35], v[28:29], v[32:33] op_sel:[0,1,0]
  v_smfmac_f32_16x16x64_bf16 v[44:47], v[16:19], v[120:127], v22
  v_add_f32 v48, v32, v33
  v_pk_mul_f32 v[36:37], v[36:37], v[28:29] op_sel_hi:[1,0]
  v_pk_fma_f32 v[36:37], v[38:39], v[28:29], v[36:37] op_sel:[0,1,0]
  v_add_f32 v49, v36, v37
  s_nop 0
  v_pk_mul_f32 v[40:41], v[40:41], v[28:29] op_sel_hi:[1,0]
  v_pk_fma_f32 v[40:41], v[42:43], v[28:29], v[40:41] op_sel:[0,1,0]
  v_add_f32 v50, v40, v41
  v_pk_mul_f32 v[44:45], v[44:45], v[28:29] op_sel_hi:[1,0]
  v_pk_fma_f32 v[44:45], v[46:47], v[28:29], v[44:45] op_sel:[0,1,0]
  v_add_f32 v51, v44, v45
  ds_write_b128 v11, v[48:51] offset:5120
  s_mov_b64 exec, 1
  ds_add_rtn_u32 v20, v26, v27 offset:48
  s_mov_b64 exec, -1
  ds_read_b128 v[32:35], v8 offset:5120
  ds_read_b128 v[36:39], v8 offset:6144
  ds_read_b128 v[40:43], v8 offset:7168
  ds_read_b128 v[44:47], v8 offset:8192
  s_waitcnt lgkmcnt(2)
  v_readfirstlane_b32 s36, v20
  v_pk_add_f32 v[32:33], v[32:33], v[36:37]
  v_pk_add_f32 v[34:35], v[34:35], v[38:39]
  s_waitcnt lgkmcnt(1)
  v_pk_add_f32 v[32:33], v[32:33], v[40:41]
  v_pk_add_f32 v[34:35], v[34:35], v[42:43]
  s_waitcnt lgkmcnt(0)
  v_pk_add_f32 v[32:33], v[32:33], v[44:45]
  v_pk_add_f32 v[34:35], v[34:35], v[46:47]
  s_cmp_eq_u32 s36, s98
  v_permlane16_swap_b32 v32, v33
  v_permlane16_swap_b32 v34, v35
  v_add_f32 v32, v32, v33
  v_add_f32 v34, v34, v35
  v_cvt_pk_bf16_f32 v32, v32, v34
  s_cbranch_scc0 L_Onear
  buffer_store_dword v32, v21, s[56:59], s66 offen sc1
  s_branch L_Odone
L_Onear:
  s_cmp_eq_u32 s36, 3
  s_cbranch_scc0 L_Odone
  buffer_store_dword v32, v21, s[56:59], s66 offen
L_Odone:
  s_cmp_eq_u32 s68, 2
  s_cbranch_scc0 L_fin
L_rw:
  ds_read_b32 v12, v26 offset:48
  s_sleep 1
  s_waitcnt lgkmcnt(0)
  v_cmp_ne_u32 vcc, 4, v12
  s_cbranch_vccnz L_rw
  v_and_b32 v12, 7, v1
  v_cmp_eq_u32 vcc, 2, v12
  s_mov_b32 s36, 33152
  s_nop 0
  v_cndmask_b32 v12, v12, 3, vcc
  v_lshlrev_b32 v12, 9, v12
  v_mov_b32 v13, 0
  s_mov_b64 exec, 0xff
  s_mov_b32 s61, 400000
  s_branch L_goR
L_goR_r:
  s_sub_u32 s61, s61, 1
  s_cbranch_scc1 L_goR_x
  s_sleep 4
  s_mov_b64 exec, vcc
L_goR:
  buffer_load_dword v13, v12, s[56:59], s36 offen sc1
  s_mov_b64 exec, -1
  s_waitcnt vmcnt(0)
  v_cmp_eq_u32 vcc, -1, v13
  s_cbranch_vccnz L_goR_r
L_goR_x:
  s_mov_b32 s61, 400000
  s_branch L_pollRa
L_pollRa_r:
  s_sub_u32 s61, s61, 1
  s_cbranch_scc1 L_pollRa_x
  s_sleep 2
  s_mov_b64 exec, vcc
L_pollRa:
  buffer_load_dword v12, v131, s[56:59], 0 offen offset:0 sc1
  buffer_load_dword v13, v131, s[56:59], 0 offen offset:1024 sc1
  buffer_load_dword v14, v131, s[56:59], 0 offen offset:128 sc1
  buffer_load_dword v15, v131, s[56:59], 0 offen offset:1152 sc1
  s_mov_b64 exec, -1
  s_waitcnt vmcnt(0)
  v_max3_u32 v16, v12, v13, v14
  v_max_u32 v16, v16, v15
  v_cmp_eq_u32 vcc, -1, v16
  s_cbranch_vccnz L_pollRa_r
L_pollRa_x:
  v_lshlrev_b32 v12, s67, v12
  v_lshlrev_b32 v13, s67, v13
  v_lshlrev_b32 v14, s67, v14
  v_lshlrev_b32 v15, s67, v15
  v_and_b32 v12, 0xffff0000, v12
  v_and_b32 v13, 0xffff0000, v13
  v_and_b32 v14, 0xffff0000, v14
  v_and_b32 v15, 0xffff0000, v15
  s_nop 1
  v_permlane32_swap_b32 v12, v13
  v_permlane32_swap_b32 v14, v15
  v_add_f32 v12, v12, v13
  v_add_f32 v14, v14, v15
  s_nop 1
  v_permlane16_swap_b32 v12, v14
  v_add_f32 v12, v12, v14
  s_nop 1
  v_add_f32_dpp v12, v12, v12 row_ror:8 row_mask:0xf bank_mask:0xf
  v_add_f32 v136, v128, v12
  v_cvt_pk_bf16_f32 v136, v136, v136
  v_lshlrev_b32 v136, 16, v136
  v_add_f32 v136, v136, v129
  s_mov_b32 s61, 400000
  s_branch L_pollRy
L_pollRy_r:
  s_sub_u32 s61, s61, 1
  s_cbranch_scc1 L_pollRy_x
  s_mov_b64 exec, vcc
L_pollRy:
  buffer_load_dwordx4 v[32:35], v132, s[52:55], 0 offen sc1
  buffer_load_dwordx4 v[36:39], v133, s[52:55], 0 offen sc1
  buffer_load_dwordx4 v[40:43], v134, s[52:55], 0 offen sc1
  s_mov_b64 exec, -1
  s_waitcnt vmcnt(0)
  v_max3_u32 v16, v32, v33, v34
  v_max3_u32 v16, v16, v35, v36
  v_max3_u32 v16, v16, v37, v38
  v_max3_u32 v16, v16, v39, v40
  v_max3_u32 v16, v16, v41, v42
  v_max_u32 v16, v16, v43
  v_cmp_eq_u32 vcc, -1, v16
  v_pk_add_f32 v[12:13], v[32:33], v[36:37]
  v_pk_add_f32 v[14:15], v[34:35], v[38:39]
  v_pk_add_f32 v[12:13], v[12:13], v[40:41]
  v_pk_add_f32 v[14:15], v[14:15], v[42:43]
  s_cbranch_vccnz L_pollRy_r
L_pollRy_x:
  v_permlane32_swap_b32 v12, v13
  v_permlane32_swap_b32 v14, v15
  v_add_f32 v12, v12, v13
  v_add_f32 v14, v14, v15
  s_nop 1
  v_permlane16_swap_b32 v12, v14
  v_add_f32 v12, v12, v14
  s_nop 1
  v_add_f32_dpp v12, v12, v12 row_ror:8 row_mask:0xf bank_mask:0xf
  v_add_f32 v12, v12, v136
  v_cvt_pk_bf16_f32 v12, v12, v12
  buffer_store_short v12, v130, s[44:47], 0 offen
  s_endpgm
L_roleF:
  s_sub_u32 s96, s69, 8
  s_lshl_b32 s97, s96, 7
  s_cmp_eq_u32 s35, 1
  s_cbranch_scc0 L_Fset
  s_add_u32 s48, s16, s97
  s_addc_u32 s49, s17, 0
  s_mov_b32 s50, 0
  s_mov_b32 s51, 0x20000
  s_sub_u32 s50, 1409024, s97
  v_lshrrev_b32 v12, 3, v1
  v_and_b32 v13, 7, v1
  v_mul_u32_u24 v12, 2752, v12
  v_lshl_add_u32 v12, v13, 4, v12
  s_mov_b32 s39, 9216
L_ldF:
  s_mov_b32 m0, s39
  s_waitcnt vmcnt(4)
  buffer_load_dwordx4 v12, s[48:51], 0 offen lds
  v_add_u32 v12, 22016, v12
  s_add_u32 s39, s39, 1024
  s_cmp_lt_u32 s39, 74752
  s_cbranch_scc1 L_ldF
  s_waitcnt vmcnt(0)
  ds_write_b32 v26, v27 offset:32
L_Fset:
  v_lshrrev_b32 v12, 1, v3
  v_lshlrev_b32 v12, 7, v12
  v_lshl_add_u32 v12, v2, 3, v12
  v_and_b32 v15, 1, v3
  v_lshl_add_u32 v12, v15, 2, v12
  v_and_b32 v13, 0xc0, v12
  v_and_b32 v14, 63, v12
  v_lshl_add_u32 v13, v13, 1, v14
  s_lshl_b32 s98, s35, 9
  buffer_load_dword v40, v13, s[40:43], s98 offen
  buffer_load_dword v41, v13, s[40:43], s98 offen offset:64
  v_lshl_add_u32 v46, v12, 1, s98
  s_mov_b64 s[44:45], s[18:19]
  s_mov_b32 s46, 2752
  s_mov_b32 s47, 0x20000
  s_lshl_b32 s36, s35, 5
  v_lshl_add_u32 v13, v2, 1, s36
  v_add_u32 v14, s97, v13
  buffer_load_ushort v44, v14, s[44:47], 0 offen
  v_lshl_add_u32 v47, v15, 7, v13
  v_lshl_add_u32 v52, v3, 3, s36
  v_lshlrev_b32 v53, 6, v15
  v_and_b32 v14, 1, v2
  v_bfe_u32 v15, v2, 1, 1
  v_lshlrev_b32 v13, 7, v14
  v_lshl_add_u32 v13, v15, 6, v13
  v_lshl_add_u32 v48, v3, 4, v13
  v_mul_u32_u24 v51, 0xaaaa, v15
  v_add_u32 v51, 0x4444, v51
  v_mul_u32_u24 v50, 0xaaaa, v14
  v_add_u32 v50, 0x4444, v50
  v_bfe_u32 v13, v2, 2, 1
  v_lshlrev_b32 v13, 10, v13
  v_lshl_add_u32 v13, v14, 6, v13
  v_lshl_add_u32 v49, v3, 4, v13
  v_mov_b32 v38, 0x3f803f80
  v_lshlrev_b32 v54, 11, v3
  v_lshl_add_u32 v54, v2, 4, v54
  v_add_u32 v55, 0x2000, v54
  s_add_u32 s98, s98, 131072
  v_cmp_gt_u32 vcc, 8, v2
  v_and_b32 v60, v38, v4
  v_and_b32 v61, v38, v5
  v_and_b32 v62, v38, v6
  v_and_b32 v63, v38, v7
  v_cndmask_b32 v56, 0, v60, vcc
  v_cndmask_b32 v60, v60, 0, vcc
  v_cndmask_b32 v57, 0, v61, vcc
  v_cndmask_b32 v61, v61, 0, vcc
  v_cndmask_b32 v58, 0, v62, vcc
  v_cndmask_b32 v62, v62, 0, vcc
  v_cndmask_b32 v59, 0, v63, vcc
  v_cndmask_b32 v63, v63, 0, vcc
  v_mov_b32 v224, 0
  v_mov_b32 v225, 0
  v_mov_b32 v226, 0
  v_mov_b32 v227, 0
  v_mov_b32 v228, 0
  v_mov_b32 v229, 0
  v_mov_b32 v230, 0
  v_mov_b32 v231, 0
  v_mov_b32 v232, 0
  v_mov_b32 v233, 0
  v_mov_b32 v234, 0
  v_mov_b32 v235, 0
  v_mov_b32 v236, 0
  v_mov_b32 v237, 0
  v_mov_b32 v238, 0
  v_mov_b32 v239, 0
  s_lshl2_add_u32 s36, s96, s35
  s_lshl_b32 s36, s36, 10
  s_add_u32 s66, s36, 147456
  s_mov_b32 s64, 0x000f000f
  s_mov_b32 s65, 0x000f000f
  v_and_b32 v11, 3, v1
  v_lshlrev_b32 v11, 3, v11
  v_bfe_u32 v14, v1, 3, 1
  v_bfe_u32 v13, v1, 2, 1
  v_lshl_add_u32 v39, v14, 3, v3
  v_mul_u32_u24 v39, 1072, v39
  v_lshl_add_u32 v39, v13, 8, v39
  s_mul_i32 s67, s35, 17152
  s_add_u32 s67, s67, 74752
  v_add3_u32 v39, v39, v11, s67
  v_lshlrev_b32 v10, 5, v13
  v_lshl_add_u32 v10, v14, 4, v10
  v_lshl_add_u32 v10, v3, 1, v10
  v_lshl_add_u32 v10, v10, 7, v11
  s_lshl_b32 s36, s35, 5
  s_add_u32 s36, s36, 9216
  v_add_u32 v10, s36, v10
L_stgF:
  ds_read_b32 v12, v26 offset:32
  s_sleep 4
  s_waitcnt lgkmcnt(0)
  v_cmp_ne_u32 vcc, 1, v12
  s_cbranch_vccnz L_stgF
  ds_read_b64_tr_b16 v[64:65], v10 offset:0
  ds_read_b64_tr_b16 v[66:67], v10 offset:128
  ds_read_b64_tr_b16 v[68:69], v10 offset:1024
  ds_read_b64_tr_b16 v[70:71], v10 offset:1152
  ds_read_b64_tr_b16 v[72:73], v10 offset:8192
  ds_read_b64_tr_b16 v[74:75], v10 offset:8320
  ds_read_b64_tr_b16 v[76:77], v10 offset:9216
  ds_read_b64_tr_b16 v[78:79], v10 offset:9344
  s_waitcnt lgkmcnt(0)
  ds_read_b64_tr_b16 v[80:81], v10 offset:16384
  ds_read_b64_tr_b16 v[82:83], v10 offset:16512
  ds_read_b64_tr_b16 v[84:85], v10 offset:17408
  ds_read_b64_tr_b16 v[86:87], v10 offset:17536
  ds_read_b64_tr_b16 v[88:89], v10 offset:24576
  ds_read_b64_tr_b16 v[90:91], v10 offset:24704
  ds_read_b64_tr_b16 v[92:93], v10 offset:25600
  ds_read_b64_tr_b16 v[94:95], v10 offset:25728
  s_waitcnt lgkmcnt(0)
  ds_read_b64_tr_b16 v[96:97], v10 offset:32768
  ds_read_b64_tr_b16 v[98:99], v10 offset:32896
  ds_read_b64_tr_b16 v[100:101], v10 offset:33792
  ds_read_b64_tr_b16 v[102:103], v10 offset:33920
  ds_read_b64_tr_b16 v[104:105], v10 offset:40960
  ds_read_b64_tr_b16 v[106:107], v10 offset:41088
  ds_read_b64_tr_b16 v[108:109], v10 offset:41984
  ds_read_b64_tr_b16 v[110:111], v10 offset:42112
  s_waitcnt lgkmcnt(0)
  ds_read_b64_tr_b16 v[112:113], v10 offset:49152
  ds_read_b64_tr_b16 v[114:115], v10 offset:49280
  ds_read_b64_tr_b16 v[116:117], v10 offset:50176
  ds_read_b64_tr_b16 v[118:119], v10 offset:50304
  ds_read_b64_tr_b16 v[120:121], v10 offset:57344
  ds_read_b64_tr_b16 v[122:123], v10 offset:57472
  ds_read_b64_tr_b16 v[124:125], v10 offset:58368
  ds_read_b64_tr_b16 v[126:127], v10 offset:58496
  s_waitcnt lgkmcnt(0)
L_locF:
  ds_read_b32 v12, v26 offset:192
  s_sleep 4
  s_waitcnt vmcnt(0) lgkmcnt(0)
  v_readfirstlane_b32 s70, v12
  s_cmp_eq_u32 s70, 0
  s_cbranch_scc1 L_locF
  v_mov_b32 v240, 0
  v_mov_b32 v16, v38
  v_mov_b32 v241, 0
  v_mov_b32 v17, v38
  v_mov_b32 v242, 0
  v_mov_b32 v18, v38
  v_mov_b32 v243, 0
  v_mov_b32 v19, v38
  v_and_b32 v42, 0xffff0000, v40
  v_and_b32 v43, 0xffff0000, v41
  v_smfmac_f32_16x16x64_bf16 v[240:243], v[16:19], v[64:71], v50
  v_smfmac_f32_16x16x64_bf16 v[240:243], v[16:19], v[72:79], v50
  v_smfmac_f32_16x16x64_bf16 v[240:243], v[16:19], v[80:87], v50
  v_smfmac_f32_16x16x64_bf16 v[240:243], v[16:19], v[88:95], v50
  v_smfmac_f32_16x16x64_bf16 v[240:243], v[16:19], v[96:103], v50
  v_smfmac_f32_16x16x64_bf16 v[240:243], v[16:19], v[104:111], v50
  v_smfmac_f32_16x16x64_bf16 v[240:243], v[16:19], v[112:119], v50
  v_smfmac_f32_16x16x64_bf16 v[240:243], v[16:19], v[120:127], v50
  v_lshlrev_b32 v40, 16, v40
  v_lshlrev_b32 v41, 16, v41
  v_lshlrev_b32 v44, 16, v44
  s_lshl_b32 s36, s96, 16
  s_add_u32 s44, s20, s36
  s_addc_u32 s45, s21, 0
  s_mov_b32 s46, 0
  s_mov_b32 s47, 0x20000
  s_sub_u32 s46, 1409024, s36
  v_add_f32 v45, v240, v241
  v_mov_b32 v240, 0
  v_mov_b32 v241, 0
  v_mov_b32 v242, 0
  v_mov_b32 v243, 0
  v_mov_b32 v244, 0
  v_mov_b32 v245, 0
  v_mov_b32 v246, 0
  v_mov_b32 v247, 0
  v_mov_b32 v248, 0
  v_mov_b32 v249, 0
  v_mov_b32 v250, 0
  v_mov_b32 v251, 0
  s_lshl_b32 s36, s35, 8
  v_lshl_add_u32 v15, v2, 4, s36
  v_lshl_add_u32 v15, v3, 10, v15
L_tr2:
  ds_read_b32 v12, v26 offset:112
  s_sleep 1
  s_waitcnt lgkmcnt(0)
  v_cmp_ne_u32 vcc, 4, v12
  s_cbranch_vccnz L_tr2
  s_add_u32 m0, s67, 0
  s_waitcnt vmcnt(7)
  buffer_load_dwordx4 v15, s[44:47], 0 offen nt lds
  v_add_u32 v15, 0x1000, v15
  s_add_u32 m0, s67, 1072
  s_waitcnt vmcnt(7)
  buffer_load_dwordx4 v15, s[44:47], 0 offen nt lds
  v_add_u32 v15, 0x1000, v15
  s_add_u32 m0, s67, 2144
  s_waitcnt vmcnt(7)
  buffer_load_dwordx4 v15, s[44:47], 0 offen nt lds
  v_add_u32 v15, 0x1000, v15
  s_add_u32 m0, s67, 3216
  s_waitcnt vmcnt(7)
  buffer_load_dwordx4 v15, s[44:47], 0 offen nt lds
  v_add_u32 v15, 0x1000, v15
  s_add_u32 m0, s67, 4288
  s_waitcnt vmcnt(7)
  buffer_load_dwordx4 v15, s[44:47], 0 offen nt lds
  v_add_u32 v15, 0x1000, v15
  s_add_u32 m0, s67, 5360
  s_waitcnt vmcnt(7)
  buffer_load_dwordx4 v15, s[44:47], 0 offen nt lds
  v_add_u32 v15, 0x1000, v15
  s_add_u32 m0, s67, 6432
  s_waitcnt vmcnt(7)
  buffer_load_dwordx4 v15, s[44:47], 0 offen nt lds
  v_add_u32 v15, 0x1000, v15
  s_add_u32 m0, s67, 7504
  s_waitcnt vmcnt(7)
  buffer_load_dwordx4 v15, s[44:47], 0 offen nt lds
  v_add_u32 v15, 0x1000, v15
  s_add_u32 m0, s67, 8576
  s_waitcnt vmcnt(7)
  buffer_load_dwordx4 v15, s[44:47], 0 offen nt lds
  v_add_u32 v15, 0x1000, v15
  s_add_u32 m0, s67, 9648
  s_waitcnt vmcnt(7)
  buffer_load_dwordx4 v15, s[44:47], 0 offen nt lds
  v_add_u32 v15, 0x1000, v15
  s_add_u32 m0, s67, 10720
  s_waitcnt vmcnt(7)
  buffer_load_dwordx4 v15, s[44:47], 0 offen nt lds
  v_add_u32 v15, 0x1000, v15
  s_add_u32 m0, s67, 11792
  s_waitcnt vmcnt(7)
  buffer_load_dwordx4 v15, s[44:47], 0 offen nt lds
  v_add_u32 v15, 0x1000, v15
  s_add_u32 m0, s67, 12864
  s_waitcnt vmcnt(7)
  buffer_load_dwordx4 v15, s[44:47], 0 offen nt lds
  v_add_u32 v15, 0x1000, v15
  s_add_u32 m0, s67, 13936
  s_waitcnt vmcnt(7)
  buffer_load_dwordx4 v15, s[44:47], 0 offen nt lds
  v_add_u32 v15, 0x1000, v15
  s_add_u32 m0, s67, 15008
  s_waitcnt vmcnt(7)
  buffer_load_dwordx4 v15, s[44:47], 0 offen nt lds
  v_add_u32 v15, 0x1000, v15
  s_add_u32 m0, s67, 16080
  s_waitcnt vmcnt(7)
  buffer_load_dwordx4 v15, s[44:47], 0 offen nt lds
  v_add_u32 v15, 0x1000, v15
  s_waitcnt vmcnt(0)
  v_and_b32 v12, 7, v1
  v_cmp_eq_u32 vcc, 2, v12
  s_mov_b32 s36, 33152
  s_nop 0
  v_cndmask_b32 v12, v12, 3, vcc
  v_lshlrev_b32 v12, 9, v12
  v_mov_b32 v13, 0
  s_mov_b64 exec, 0xff
  s_mov_b32 s61, 400000
  buffer_load_dword v13, v12, s[56:59], s36 offen sc1
  s_mov_b64 exec, -1
  ds_read_b64_tr_b16 v[128:129], v39 offset:0
  ds_read_b64_tr_b16 v[130:131], v39 offset:512
  ds_read_b64_tr_b16 v[132:133], v39 offset:4288
  ds_read_b64_tr_b16 v[134:135], v39 offset:4800
  ds_read_b64_tr_b16 v[136:137], v39 offset:32
  ds_read_b64_tr_b16 v[138:139], v39 offset:544
  ds_read_b64_tr_b16 v[140:141], v39 offset:4320
  ds_read_b64_tr_b16 v[142:143], v39 offset:4832
  ds_read_b64_tr_b16 v[144:145], v39 offset:64
  ds_read_b64_tr_b16 v[146:147], v39 offset:576
  ds_read_b64_tr_b16 v[148:149], v39 offset:4352
  ds_read_b64_tr_b16 v[150:151], v39 offset:4864
  ds_read_b64_tr_b16 v[152:153], v39 offset:96
  ds_read_b64_tr_b16 v[154:155], v39 offset:608
  ds_read_b64_tr_b16 v[156:157], v39 offset:4384
  ds_read_b64_tr_b16 v[158:159], v39 offset:4896
  ds_read_b64_tr_b16 v[160:161], v39 offset:128
  ds_read_b64_tr_b16 v[162:163], v39 offset:640
  ds_read_b64_tr_b16 v[164:165], v39 offset:4416
  ds_read_b64_tr_b16 v[166:167], v39 offset:4928
  ds_read_b64_tr_b16 v[168:169], v39 offset:160
  ds_read_b64_tr_b16 v[170:171], v39 offset:672
  ds_read_b64_tr_b16 v[172:173], v39 offset:4448
  ds_read_b64_tr_b16 v[174:175], v39 offset:4960
  ds_read_b64_tr_b16 v[176:177], v39 offset:192
  ds_read_b64_tr_b16 v[178:179], v39 offset:704
  ds_read_b64_tr_b16 v[180:181], v39 offset:4480
  ds_read_b64_tr_b16 v[182:183], v39 offset:4992
  ds_read_b64_tr_b16 v[184:185], v39 offset:224
  ds_read_b64_tr_b16 v[186:187], v39 offset:736
  ds_read_b64_tr_b16 v[188:189], v39 offset:4512
  ds_read_b64_tr_b16 v[190:191], v39 offset:5024
  s_branch L_goF_w
L_goF_r:
  s_sub_u32 s61, s61, 1
  s_cbranch_scc1 L_goF_x
  s_mov_b64 exec, vcc
L_goF:
  buffer_load_dword v13, v12, s[56:59], s36 offen sc1
  s_mov_b64 exec, -1
L_goF_w:
  s_waitcnt vmcnt(0)
  v_cmp_eq_u32 vcc, -1, v13
  s_cbranch_vccnz L_goF_r
L_goF_x:
  s_mov_b32 s61, 400000
  s_branch L_pollF
L_pollF_r:
  s_sub_u32 s61, s61, 1
  s_cbranch_scc1 L_pollF_x
  s_mov_b64 exec, vcc
L_pollF:
  buffer_load_dwordx4 v[192:195], v54, s[56:59], s98 offen offset:0 sc1
  buffer_load_dwordx4 v[196:199], v55, s[56:59], s98 offen offset:0 sc1
  buffer_load_dwordx4 v[200:203], v54, s[56:59], s98 offen offset:256 sc1
  buffer_load_dwordx4 v[204:207], v55, s[56:59], s98 offen offset:256 sc1
  s_mov_b64 exec, -1
  s_waitcnt vmcnt(0)
  v_mfma_f32_16x16x32_bf16 v[28:31], v[56:59], v[192:195], v[40:43]
  v_max3_u32 v32, v192, v193, v194
  v_max3_u32 v32, v32, v195, v196
  v_mfma_f32_16x16x32_bf16 v[28:31], v[56:59], v[196:199], v[28:31]
  v_max3_u32 v32, v32, v197, v198
  v_max3_u32 v32, v32, v199, v200
  v_mfma_f32_16x16x32_bf16 v[28:31], v[60:63], v[200:203], v[28:31]
  v_max3_u32 v32, v32, v201, v202
  v_max3_u32 v32, v32, v203, v204
  v_mfma_f32_16x16x32_bf16 v[28:31], v[60:63], v[204:207], v[28:31]
  v_max3_u32 v32, v32, v205, v206
  v_max_u32 v32, v32, v207
  v_cmp_eq_u32 vcc, -1, v32
  s_nop 3
  s_cbranch_vccnz L_pollF_r
L_pollF_x:
  v_cvt_pk_bf16_f32 v28, v28, v29
  v_cvt_pk_bf16_f32 v29, v30, v31
  ds_write_b64 v46, v[28:29] offset:3072
  v_dot2_f32_bf16 v32, v28, v38, 0
  v_dot2_f32_bf16 v33, v28, v28, 0
  v_dot2_f32_bf16 v32, v29, v38, v32
  v_dot2_f32_bf16 v33, v29, v29, v33
  s_nop 0
  s_nop 0
  v_add_f32_dpp v32, v32, v32 quad_perm:[1,0,3,2] row_mask:0xf bank_mask:0xf
  v_add_f32_dpp v33, v33, v33 quad_perm:[1,0,3,2] row_mask:0xf bank_mask:0xf
  s_nop 0
  v_add_f32_dpp v32, v32, v32 quad_perm:[2,3,0,1] row_mask:0xf bank_mask:0xf
  v_add_f32_dpp v33, v33, v33 quad_perm:[2,3,0,1] row_mask:0xf bank_mask:0xf
  s_nop 0
  v_add_f32_dpp v32, v32, v32 row_ror:4 row_mask:0xf bank_mask:0xf
  v_add_f32_dpp v33, v33, v33 row_ror:4 row_mask:0xf bank_mask:0xf
  s_nop 0
  v_add_f32_dpp v32, v32, v32 row_ror:8 row_mask:0xf bank_mask:0xf
  v_add_f32_dpp v33, v33, v33 row_ror:8 row_mask:0xf bank_mask:0xf
  ds_write_b64 v52, v[32:33] offset:544
  s_waitcnt lgkmcnt(0)
  s_barrier
  ds_read_b128 v[192:195], v49 offset:3072
  ds_read_b128 v[12:15], v53 offset:544
  ds_read_b128 v[16:19], v53 offset:560
  ds_read_b128 v[196:199], v49 offset:3200
  ds_read_b128 v[20:23], v53 offset:576
  ds_read_b128 v[28:31], v53 offset:592
  ds_read_b128 v[200:203], v49 offset:3328
  ds_read_b128 v[204:207], v49 offset:3456
  ds_read_b128 v[208:211], v49 offset:3584
  ds_read_b128 v[212:215], v49 offset:3712
  ds_read_b128 v[216:219], v49 offset:3840
  ds_read_b128 v[220:223], v49 offset:3968
  s_waitcnt lgkmcnt(11)
  v_smfmac_f32_16x16x64_bf16 v[240:243], v[192:195], v[64:71], v50
  s_waitcnt lgkmcnt(8)
  v_smfmac_f32_16x16x64_bf16 v[240:243], v[196:199], v[72:79], v50
  v_pk_add_f32 v[12:13], v[12:13], v[14:15]
  v_pk_add_f32 v[16:17], v[16:17], v[18:19]
  v_pk_add_f32 v[12:13], v[12:13], v[16:17]
  s_waitcnt lgkmcnt(5)
  v_smfmac_f32_16x16x64_bf16 v[240:243], v[200:203], v[80:87], v50
  v_pk_add_f32 v[20:21], v[20:21], v[22:23]
  v_pk_add_f32 v[28:29], v[28:29], v[30:31]
  v_pk_add_f32 v[12:13], v[12:13], v[20:21]
  s_waitcnt lgkmcnt(4)
  v_smfmac_f32_16x16x64_bf16 v[240:243], v[204:207], v[88:95], v50
  v_pk_add_f32 v[12:13], v[12:13], v[28:29]
  v_mul_f32 v32, 0x3b000000, v12
  v_mul_f32 v33, 0x3b000000, v13
  s_waitcnt lgkmcnt(3)
  v_smfmac_f32_16x16x64_bf16 v[240:243], v[208:211], v[96:103], v50
  v_fma_f32 v33, -v32, v32, v33
  v_max_f32 v36, 0, v33
  s_waitcnt lgkmcnt(2)
  v_smfmac_f32_16x16x64_bf16 v[240:243], v[212:215], v[104:111], v50
  v_cvt_pk_bf16_f32 v36, v36, v36
  v_lshlrev_b32 v36, 16, v36
  s_waitcnt lgkmcnt(1)
  v_smfmac_f32_16x16x64_bf16 v[240:243], v[216:219], v[112:119], v50
  v_add_f32 v36, 0x3727c5ac, v36
  v_cvt_pk_bf16_f32 v36, v36, v36
  s_waitcnt lgkmcnt(0)
  v_smfmac_f32_16x16x64_bf16 v[240:243], v[220:223], v[120:127], v50
  v_lshlrev_b32 v36, 16, v36
  v_sqrt_f32 v36, v36
  v_cvt_pk_bf16_f32 v32, v32, v32
  v_lshlrev_b32 v32, 16, v32
  v_cvt_pk_bf16_f32 v36, v36, v36
  v_lshlrev_b32 v36, 16, v36
  v_rcp_f32 v36, v36
  s_nop 0
  v_add_f32 v28, v240, v241
  v_fma_f32 v28, -v32, v45, v28
  v_fma_f32 v28, v28, v36, v44
  v_max_f32 v28, 0, v28
  v_mul_f32 v28, v28, v28
  v_cvt_pk_bf16_f32 v28, v28, v28
  ds_write_b16 v47, v28 offset:672
  s_mov_b64 exec, s[64:65]
  s_waitcnt lgkmcnt(0)
  s_barrier
  ds_read_b128 v[224:227], v48 offset:672
  s_lshl_b64 exec, s[64:65], 4
  ds_read_b128 v[228:231], v48 offset:672
  s_lshl_b64 exec, s[64:65], 8
  ds_read_b128 v[232:235], v48 offset:672
  s_lshl_b64 exec, s[64:65], 12
  ds_read_b128 v[236:239], v48 offset:672
  s_mov_b64 exec, -1
  s_cmp_eq_u32 s70, 7
  s_waitcnt lgkmcnt(3)
  v_smfmac_f32_16x16x64_bf16 v[244:247], v[224:227], v[128:135], v51
  v_smfmac_f32_16x16x64_bf16 v[248:251], v[224:227], v[160:167], v51
  s_waitcnt lgkmcnt(2)
  v_smfmac_f32_16x16x64_bf16 v[244:247], v[228:231], v[136:143], v51
  v_smfmac_f32_16x16x64_bf16 v[248:251], v[228:231], v[168:175], v51
  s_waitcnt lgkmcnt(1)
  v_smfmac_f32_16x16x64_bf16 v[244:247], v[232:235], v[144:151], v51
  v_smfmac_f32_16x16x64_bf16 v[248:251], v[232:235], v[176:183], v51
  s_waitcnt lgkmcnt(0)
  v_smfmac_f32_16x16x64_bf16 v[244:247], v[236:239], v[152:159], v51
  v_smfmac_f32_16x16x64_bf16 v[248:251], v[236:239], v[184:191], v51
  s_nop 5
  s_cbranch_scc0 L_F2far
  v_pk_add_f32 v[28:29], v[244:245], v[246:247]
  v_pk_add_f32 v[30:31], v[248:249], v[250:251]
  buffer_store_dwordx4 v[28:31], v8, s[56:59], s66 offen
  s_branch L_fin
L_F2far:
  v_pk_add_f32 v[28:29], v[244:245], v[246:247]
  v_pk_add_f32 v[30:31], v[248:249], v[250:251]
  buffer_store_dwordx4 v[28:31], v8, s[56:59], s66 offen sc1
L_fin:
L_end:
  s_endpgm
.section .rodata,"a"
.p2align 6
.amdhsa_kernel sequential_preLN__mha_block_cached__dense_activation_squared_relu__decode_kernel
  .amdhsa_next_free_vgpr 252
  .amdhsa_next_free_sgpr 100
  .amdhsa_accum_offset 252
  .amdhsa_group_segment_fixed_size 0
  .amdhsa_kernarg_size 104
  .amdhsa_user_sgpr_count 2
  .amdhsa_user_sgpr_kernarg_segment_ptr 1
  .amdhsa_system_sgpr_workgroup_id_x 1
  .amdhsa_float_denorm_mode_32 3
.end_amdhsa_kernel
```
